```python
import torch

def _softmax(x, axis=-1):
    return torch.softmax(x, dim=axis)

def _gelu(x):
    return torch.nn.functional.gelu(x, approximate='tanh')

def _silu(x):
    return torch.nn.functional.silu(x)

def _sigmoid(x):
    return torch.sigmoid(x)

def _layernorm(x, axis=-1, eps=1e-05):
    m = x.mean(dim=axis, keepdim=True)
    v = x.var(dim=axis, keepdim=True, unbiased=False)
    return (x - m) / torch.sqrt(v + eps)

def _scatter_add(tgt, idx, src, axis=0):
    return tgt.clone().index_add_(axis, idx, src)

def _segment_sum(src, seg, n):
    out = torch.zeros((n,) + src.shape[1:], dtype=src.dtype)
    return out.index_add_(0, seg, src)

def _pad(x, pw):
    flat = tuple((v for pair in reversed(pw) for v in pair))
    return torch.nn.functional.pad(x, flat)
kernel_name = 'standalone__video_video_swin__vision'

def setup_inputs():

    _w = lambda a: (lambda t: t.to(torch.bfloat16) if t.is_floating_point() else t)(torch.as_tensor(a))
    T = 4
    H = W = 224 // 8 * 8
    C, win = (96, 8)
    return {'x': _w((lambda *s: torch.randn(*s, dtype=torch.bfloat16) * 0.1)(1, T, H, W, C)), 'wqkv_t': _w((lambda *s: torch.randn(*s, dtype=torch.bfloat16) * 0.1)(C, 3 * C)), 'wo_t': _w((lambda *s: torch.randn(*s, dtype=torch.bfloat16) * 0.1)(C, C)), 'wqkv_s': _w((lambda *s: torch.randn(*s, dtype=torch.bfloat16) * 0.1)(C, 3 * C)), 'wo_s': _w((lambda *s: torch.randn(*s, dtype=torch.bfloat16) * 0.8)(C, C))}

def reference(x, wqkv_t, wo_t, wqkv_s, wo_s):
    B, T, H, W, C = x.shape
    win = 8
    scale = C ** (-0.5)
    h = _layernorm(x, axis=-1)
    ht = (lambda x, *d: x.permute(*d))(h, 0, 2, 3, 1, 4).reshape(B * H * W, T, C)
    qkv = ht @ wqkv_t
    q, k, v = (qkv[..., :C].clone(), qkv[..., C:2 * C].clone(), qkv[..., 2 * C:].clone())
    p = _softmax(torch.einsum('btc,bsc->bts', q, k) * scale, axis=-1)
    ot = torch.einsum('bts,bsc->btc', p, v) @ wo_t
    ot = (lambda x, *d: x.permute(*d))(ot.reshape(B, H, W, T, C), 0, 3, 1, 2, 4)
    x = x + ot
    h = _layernorm(x, axis=-1)
    nh, nw = (H // win, W // win)
    hs = h.reshape(B * T, nh, win, nw, win, C)
    hw = (lambda x, *d: x.permute(*d))(hs, 0, 1, 3, 2, 4, 5).reshape(B * T * nh * nw, win * win, C)
    qkv = hw @ wqkv_s
    q, k, v = (qkv[..., :C].clone(), qkv[..., C:2 * C].clone(), qkv[..., 2 * C:].clone())
    p = _softmax(torch.einsum('bqc,bkc->bqk', q, k) * scale, axis=-1)
    os = torch.einsum('bqk,bkc->bqc', p, v) @ wo_s
    os = (lambda x, *d: x.permute(*d))(os.reshape(B * T, nh, nw, win, win, C), 0, 1, 3, 2, 4, 5)
    os = os.reshape(B, T, H, W, C)
    return x + os
```

```asm
; @launch kernel=fold_kernel grid=(36,1,1) block=(64,1,1) lds=0
; @launch kernel=standalone__video_video_swin__vision_kernel grid=(816,1,1) block=(256,1,1) lds=81920
.amdgcn_target "amdgcn-amd-amdhsa--gfx950"
.text
.globl fold_kernel
.p2align 8
.type fold_kernel,@function
fold_kernel:
  s_cmp_ge_u32 s2, 36
  s_cbranch_scc1 L_fold_done
  s_load_dwordx4 s[4:7], s[0:1], 8
  s_load_dwordx4 s[8:11], s[0:1], 24
  s_load_dwordx2 s[12:13], s[0:1], 56
  s_mul_i32 s14, s2, 29
  s_lshr_b32 s14, s14, 8
  s_mul_i32 s15, s14, 9
  s_sub_u32 s15, s2, s15
  s_mul_i32 s16, s15, 86
  s_lshr_b32 s16, s16, 8
  s_mul_i32 s17, s16, 3
  s_sub_u32 s17, s15, s17
  s_and_b32 s18, s14, 1
  s_lshr_b32 s19, s14, 1
  v_and_b32 v1, 31, v0
  v_lshrrev_b32 v2, 5, v0
  v_and_b32 v3, 19, v1
  v_and_b32 v4, 4, v1
  v_lshlrev_b32 v4, 1, v4
  v_or_b32 v3, v3, v4
  v_and_b32 v4, 8, v1
  v_lshrrev_b32 v4, 1, v4
  v_or_b32 v3, v3, v4
  s_waitcnt lgkmcnt(0)
  s_cmp_eq_u32 s19, 0
  s_cselect_b32 s20, s4, s8
  s_cselect_b32 s21, s5, s9
  s_cselect_b32 s22, s6, s10
  s_cselect_b32 s23, s7, s11
  s_lshl_b32 s24, s16, 5
  v_add_u32 v5, s24, v3
  s_movk_i32 s25, 576
  v_mul_lo_u32 v5, v5, s25
  v_lshlrev_b32 v6, 4, v2
  v_add_u32 v5, v5, v6
  s_mul_i32 s26, s18, 384
  v_add_u32 v5, s26, v5
  global_load_dwordx4 v[16:19], v5, s[20:21] offset:0
  global_load_dwordx4 v[20:23], v5, s[20:21] offset:32
  global_load_dwordx4 v[24:27], v5, s[20:21] offset:64
  global_load_dwordx4 v[28:31], v5, s[20:21] offset:96
  global_load_dwordx4 v[32:35], v5, s[20:21] offset:128
  global_load_dwordx4 v[36:39], v5, s[20:21] offset:160
  s_lshl_b32 s24, s17, 5
  v_add_u32 v7, s24, v3
  s_cmp_eq_u32 s18, 0
  s_cbranch_scc0 L_fold_wo
  v_mul_lo_u32 v8, v7, s25
  v_add_u32 v8, v8, v6
  global_load_dwordx4 v[40:43], v8, s[20:21] offset:192
  global_load_dwordx4 v[44:47], v8, s[20:21] offset:224
  global_load_dwordx4 v[48:51], v8, s[20:21] offset:256
  global_load_dwordx4 v[52:55], v8, s[20:21] offset:288
  global_load_dwordx4 v[56:59], v8, s[20:21] offset:320
  global_load_dwordx4 v[60:63], v8, s[20:21] offset:352
  s_branch L_fold_mm
L_fold_wo:
  v_lshlrev_b32 v8, 1, v7
  s_movk_i32 s27, 1536
  v_mul_lo_u32 v9, v2, s27
  v_add_u32 v8, v8, v9
  global_load_ushort v96, v8, s[22:23] offset:0
  global_load_ushort v97, v8, s[22:23] offset:192
  global_load_ushort v98, v8, s[22:23] offset:384
  global_load_ushort v99, v8, s[22:23] offset:576
  global_load_ushort v100, v8, s[22:23] offset:768
  global_load_ushort v101, v8, s[22:23] offset:960
  global_load_ushort v102, v8, s[22:23] offset:1152
  global_load_ushort v103, v8, s[22:23] offset:1344
  v_add_u32 v8, 0xc00, v8
  global_load_ushort v104, v8, s[22:23] offset:0
  global_load_ushort v105, v8, s[22:23] offset:192
  global_load_ushort v106, v8, s[22:23] offset:384
  global_load_ushort v107, v8, s[22:23] offset:576
  global_load_ushort v108, v8, s[22:23] offset:768
  global_load_ushort v109, v8, s[22:23] offset:960
  global_load_ushort v110, v8, s[22:23] offset:1152
  global_load_ushort v111, v8, s[22:23] offset:1344
  v_add_u32 v8, 0xc00, v8
  global_load_ushort v112, v8, s[22:23] offset:0
  global_load_ushort v113, v8, s[22:23] offset:192
  global_load_ushort v114, v8, s[22:23] offset:384
  global_load_ushort v115, v8, s[22:23] offset:576
  global_load_ushort v116, v8, s[22:23] offset:768
  global_load_ushort v117, v8, s[22:23] offset:960
  global_load_ushort v118, v8, s[22:23] offset:1152
  global_load_ushort v119, v8, s[22:23] offset:1344
  v_add_u32 v8, 0xc00, v8
  global_load_ushort v120, v8, s[22:23] offset:0
  global_load_ushort v121, v8, s[22:23] offset:192
  global_load_ushort v122, v8, s[22:23] offset:384
  global_load_ushort v123, v8, s[22:23] offset:576
  global_load_ushort v124, v8, s[22:23] offset:768
  global_load_ushort v125, v8, s[22:23] offset:960
  global_load_ushort v126, v8, s[22:23] offset:1152
  global_load_ushort v127, v8, s[22:23] offset:1344
  v_add_u32 v8, 0xc00, v8
  global_load_ushort v128, v8, s[22:23] offset:0
  global_load_ushort v129, v8, s[22:23] offset:192
  global_load_ushort v130, v8, s[22:23] offset:384
  global_load_ushort v131, v8, s[22:23] offset:576
  global_load_ushort v132, v8, s[22:23] offset:768
  global_load_ushort v133, v8, s[22:23] offset:960
  global_load_ushort v134, v8, s[22:23] offset:1152
  global_load_ushort v135, v8, s[22:23] offset:1344
  v_add_u32 v8, 0xc00, v8
  global_load_ushort v136, v8, s[22:23] offset:0
  global_load_ushort v137, v8, s[22:23] offset:192
  global_load_ushort v138, v8, s[22:23] offset:384
  global_load_ushort v139, v8, s[22:23] offset:576
  global_load_ushort v140, v8, s[22:23] offset:768
  global_load_ushort v141, v8, s[22:23] offset:960
  global_load_ushort v142, v8, s[22:23] offset:1152
  global_load_ushort v143, v8, s[22:23] offset:1344
  s_waitcnt vmcnt(0)
  v_lshl_or_b32 v40, v97, 16, v96
  v_lshl_or_b32 v41, v99, 16, v98
  v_lshl_or_b32 v42, v101, 16, v100
  v_lshl_or_b32 v43, v103, 16, v102
  v_lshl_or_b32 v44, v105, 16, v104
  v_lshl_or_b32 v45, v107, 16, v106
  v_lshl_or_b32 v46, v109, 16, v108
  v_lshl_or_b32 v47, v111, 16, v110
  v_lshl_or_b32 v48, v113, 16, v112
  v_lshl_or_b32 v49, v115, 16, v114
  v_lshl_or_b32 v50, v117, 16, v116
  v_lshl_or_b32 v51, v119, 16, v118
  v_lshl_or_b32 v52, v121, 16, v120
  v_lshl_or_b32 v53, v123, 16, v122
  v_lshl_or_b32 v54, v125, 16, v124
  v_lshl_or_b32 v55, v127, 16, v126
  v_lshl_or_b32 v56, v129, 16, v128
  v_lshl_or_b32 v57, v131, 16, v130
  v_lshl_or_b32 v58, v133, 16, v132
  v_lshl_or_b32 v59, v135, 16, v134
  v_lshl_or_b32 v60, v137, 16, v136
  v_lshl_or_b32 v61, v139, 16, v138
  v_lshl_or_b32 v62, v141, 16, v140
  v_lshl_or_b32 v63, v143, 16, v142
  s_nop 1
L_fold_mm:
  s_waitcnt vmcnt(0)
  v_mfma_f32_32x32x16_bf16 v[64:79], v[16:19], v[40:43], 0
  v_mfma_f32_32x32x16_bf16 v[64:79], v[20:23], v[44:47], v[64:79]
  v_mfma_f32_32x32x16_bf16 v[64:79], v[24:27], v[48:51], v[64:79]
  v_mfma_f32_32x32x16_bf16 v[64:79], v[28:31], v[52:55], v[64:79]
  v_mfma_f32_32x32x16_bf16 v[64:79], v[32:35], v[56:59], v[64:79]
  v_mfma_f32_32x32x16_bf16 v[64:79], v[36:39], v[60:63], v[64:79]
  s_mov_b32 s28, 0x3e16c740
  s_cmp_eq_u32 s18, 0
  s_cselect_b32 s28, s28, 1.0
  s_mul_i32 s30, s16, 6
  s_add_u32 s30, s30, s17
  s_mul_i32 s31, s17, 6
  s_lshl_b32 s32, s16, 1
  s_add_u32 s31, s31, s32
  s_add_u32 s31, s31, 18
  s_cmp_eq_u32 s18, 0
  s_cselect_b32 s30, s30, s31
  s_movk_i32 s31, 3072
  s_movk_i32 s32, 1024
  s_cselect_b32 s31, s31, s32
  s_lshl_b32 s30, s30, 10
  s_mul_i32 s29, s19, 36864
  s_add_u32 s29, s29, s30
  v_lshlrev_b32 v10, 4, v0
  v_add_u32 v10, s29, v10
  v_add_u32 v11, s31, v10
  s_nop 15
  v_mul_f32 v64, s28, v64
  v_mul_f32 v65, s28, v65
  v_mul_f32 v66, s28, v66
  v_mul_f32 v67, s28, v67
  v_mul_f32 v68, s28, v68
  v_mul_f32 v69, s28, v69
  v_mul_f32 v70, s28, v70
  v_mul_f32 v71, s28, v71
  v_mul_f32 v72, s28, v72
  v_mul_f32 v73, s28, v73
  v_mul_f32 v74, s28, v74
  v_mul_f32 v75, s28, v75
  v_mul_f32 v76, s28, v76
  v_mul_f32 v77, s28, v77
  v_mul_f32 v78, s28, v78
  v_mul_f32 v79, s28, v79
  v_cvt_pk_bf16_f32 v80, v64, v65
  v_cvt_pk_bf16_f32 v81, v66, v67
  v_cvt_pk_bf16_f32 v82, v68, v69
  v_cvt_pk_bf16_f32 v83, v70, v71
  v_cvt_pk_bf16_f32 v84, v72, v73
  v_cvt_pk_bf16_f32 v85, v74, v75
  v_cvt_pk_bf16_f32 v86, v76, v77
  v_cvt_pk_bf16_f32 v87, v78, v79
  global_store_dwordx4 v10, v[80:83], s[12:13]
  global_store_dwordx4 v11, v[84:87], s[12:13]
L_fold_done:
  s_endpgm
.globl standalone__video_video_swin__vision_kernel
.p2align 8
.type standalone__video_video_swin__vision_kernel,@function
standalone__video_video_swin__vision_kernel:
  s_cmp_ge_u32 s2, 816
  s_cbranch_scc1 L_main_done
  s_load_dwordx2 s[4:5], s[0:1], 0
  s_load_dwordx4 s[8:11], s[0:1], 48
  s_load_dwordx2 s[6:7], s[0:1], 40
  s_mov_b32 s61, 1
  s_sub_u32 s3, s2, 32
  s_mov_b32 s62, s2
  s_cmp_lt_u32 s2, 32
  s_cselect_b32 s61, 0, s61
  s_sub_u32 s28, s2, 784
  s_cmp_ge_u32 s2, 784
  s_cselect_b32 s61, 2, s61
  s_cselect_b32 s62, s28, s62
  s_add_u32 s28, s62, 752
  s_cmp_eq_u32 s61, 1
  s_cselect_b32 s3, s3, s28
  v_lshrrev_b32 v8, 6, v0
  v_and_b32 v1, 63, v0
  v_readfirstlane_b32 s24, v8
  s_mul_i32 s25, s3, 2341
  s_lshr_b32 s25, s25, 16
  s_mul_i32 s26, s25, 28
  s_sub_u32 s26, s3, s26
  s_mul_i32 s27, s25, 344064
  s_mul_i32 s28, s26, 1536
  s_add_u32 s27, s27, s28
  s_mov_b32 s30, 0x3f803f80
  s_mov_b32 s31, 0xffff0000
  v_lshrrev_b32 v9, 5, v1
  v_and_b32 v10, 31, v1
  v_and_b32 v11, 3, v1
  v_lshrrev_b32 v12, 2, v10
  s_mov_b32 s48, 9633792
  v_mul_lo_u32 v2, v11, s48
  v_mul_u32_u24 v13, 0xc0, v12
  v_add_u32 v2, v2, v13
  v_lshlrev_b32 v13, 4, v9
  v_add_u32 v2, v2, v13
  v_lshlrev_b32 v7, 4, v0
  v_lshlrev_b32 v6, 4, v1
  s_mul_i32 s46, s24, 86016
  s_add_u32 s46, s46, s27
  s_add_u32 s47, s46, 43008
  s_waitcnt lgkmcnt(0)
  s_mov_b32 s12, s4
  s_and_b32 s13, s5, 0xffff
  s_mov_b32 s14, 38535168
  s_mov_b32 s15, 0x20000
  s_mov_b32 s16, s6
  s_and_b32 s17, s7, 0xffff
  s_mov_b32 s18, 38535168
  s_mov_b32 s19, 0x20000
  s_mov_b32 s20, s10
  s_and_b32 s21, s11, 0xffff
  s_mov_b32 s22, 1703936
  s_mov_b32 s23, 0x20000
  s_mul_i32 s63, s62, 49152
  s_mul_i32 s48, s24, 12288
  s_add_u32 s63, s63, s48
  s_add_u32 s63, s63, 131072
  s_cmp_eq_u32 s61, 2
  s_cbranch_scc1 L_skipld
  s_mov_b32 s48, 4096
  buffer_load_dwordx4 v[112:115], v7, s[20:23], s48 offen offset:0
  s_mov_b32 s48, 8192
  buffer_load_dwordx4 v[116:119], v7, s[20:23], s48 offen offset:0
  s_mov_b32 s48, 12288
  buffer_load_dwordx4 v[120:123], v7, s[20:23], s48 offen offset:0
  s_mov_b32 s48, 16384
  buffer_load_dwordx4 v[124:127], v7, s[20:23], s48 offen offset:0
  s_mov_b32 s48, 20480
  buffer_load_dwordx4 v[128:131], v7, s[20:23], s48 offen offset:0
  s_mov_b32 s48, 24576
  buffer_load_dwordx4 v[132:135], v7, s[20:23], s48 offen offset:0
  s_mov_b32 s48, 28672
  buffer_load_dwordx4 v[136:139], v7, s[20:23], s48 offen offset:0
  s_mov_b32 s48, 32768
  buffer_load_dwordx4 v[140:143], v7, s[20:23], s48 offen offset:0
  s_mov_b32 s84, -1
  s_mov_b32 s85, 0
  v_add_u32 v176, 0x400, v6
  v_add_u32 v178, 42496, v6
  v_cndmask_b32 v176, v178, v176, s[84:85]
  v_add_u32 v177, 43520, v6
  s_mul_i32 s86, s24, 12288
  s_add_u32 s86, s86, 32768
  s_mov_b32 s48, s46
  s_add_u32 m0, s86, 0
  s_nop 0
  buffer_load_dwordx4 v6, s[12:15], s48 offen lds
  s_add_u32 m0, s86, 1024
  s_nop 0
  buffer_load_dwordx4 v176, s[12:15], s48 offen lds
  s_add_u32 m0, s86, 2048
  s_nop 0
  buffer_load_dwordx4 v177, s[12:15], s48 offen lds
  s_add_u32 s48, s48, 9633792
  s_add_u32 m0, s86, 3072
  v_xor_b32 v178, 16, v6
  buffer_load_dwordx4 v178, s[12:15], s48 offen lds
  s_add_u32 m0, s86, 4096
  v_xor_b32 v179, 16, v176
  buffer_load_dwordx4 v179, s[12:15], s48 offen lds
  s_add_u32 m0, s86, 5120
  v_xor_b32 v178, 16, v177
  buffer_load_dwordx4 v178, s[12:15], s48 offen lds
  s_add_u32 s48, s48, 9633792
  s_add_u32 m0, s86, 6144
  v_xor_b32 v178, 32, v6
  buffer_load_dwordx4 v178, s[12:15], s48 offen lds
  s_add_u32 m0, s86, 7168
  v_xor_b32 v179, 32, v176
  buffer_load_dwordx4 v179, s[12:15], s48 offen lds
  s_add_u32 m0, s86, 8192
  v_xor_b32 v178, 32, v177
  buffer_load_dwordx4 v178, s[12:15], s48 offen lds
  s_add_u32 s48, s48, 9633792
  s_add_u32 m0, s86, 9216
  v_xor_b32 v178, 48, v6
  buffer_load_dwordx4 v178, s[12:15], s48 offen lds
  s_add_u32 m0, s86, 10240
  v_xor_b32 v179, 48, v176
  buffer_load_dwordx4 v179, s[12:15], s48 offen lds
  s_add_u32 m0, s86, 11264
  v_xor_b32 v178, 48, v177
  buffer_load_dwordx4 v178, s[12:15], s48 offen lds
  v_xor_b32 v176, v9, v11
  v_lshlrev_b32 v176, 4, v176
  v_mul_u32_u24 v177, 0xc0, v12
  v_add_u32 v176, v176, v177
  v_mul_u32_u24 v177, 0xc00, v11
  v_add_u32 v176, v176, v177
  v_add_u32 v2, s86, v176
  buffer_load_dwordx4 v[240:243], v6, s[20:23], 0 offen offset:0
  buffer_load_dwordx4 v[244:247], v6, s[20:23], 0 offen offset:1024
  buffer_load_dwordx4 v[248:251], v6, s[20:23], 0 offen offset:2048
  buffer_load_dwordx4 v[252:255], v6, s[20:23], 0 offen offset:3072
L_skipld:
  s_mov_b32 s52, 40960
  s_mov_b32 s53, 45056
  s_mov_b32 s54, 49152
  s_mov_b32 s55, 53248
  s_mov_b32 s56, 57344
  s_mov_b32 s57, 61440
  s_mov_b32 s58, 65536
  s_mov_b32 s59, 69632
  s_mov_b32 s60, 36864
  s_mul_i32 s50, s24, 9633792
  s_add_u32 s50, s50, s27
  s_add_u32 s51, s50, 172032
  v_lshrrev_b32 v15, 3, v10
  v_cmp_eq_u32 s[32:33], 1, v15
  v_cmp_eq_u32 s[34:35], 2, v15
  v_cmp_eq_u32 s[36:37], 3, v15
  v_and_b32 v14, 1, v12
  v_xor_b32 v14, v14, v9
  v_lshlrev_b32 v13, 2, v14
  v_add_u32 v13, v13, v15
  v_cmp_eq_u32 s[38:39], 0, v13
  v_cmp_eq_u32 s[40:41], 1, v13
  v_cmp_eq_u32 s[42:43], 2, v13
  v_cmp_eq_u32 s[44:45], 3, v13
  v_lshlrev_b32 v14, 3, v14
  v_lshlrev_b32 v13, 1, v15
  v_add_u32 v14, v14, v13
  v_bfe_u32 v13, v10, 1, 1
  v_add_u32 v14, v14, v13
  v_cmp_eq_u32 s[64:65], 0, v14
  v_cmp_eq_u32 s[66:67], 1, v14
  v_cmp_eq_u32 s[68:69], 2, v14
  v_cmp_eq_u32 s[70:71], 3, v14
  v_cmp_eq_u32 s[72:73], 4, v14
  v_cmp_eq_u32 s[74:75], 5, v14
  v_cmp_eq_u32 s[76:77], 6, v14
  v_cmp_eq_u32 s[78:79], 7, v14
  v_lshlrev_b32 v13, 1, v11
  v_xor_b32 v13, v13, v12
  v_lshlrev_b32 v14, 5, v9
  v_add_u32 v13, v13, v14
  v_lshlrev_b32 v13, 4, v13
  v_mul_u32_u24 v14, 0x3000, v11
  v_add_u32 v3, v13, v14
  s_lshr_b32 s48, s24, 1
  s_mul_i32 s48, s48, 6144
  s_and_b32 s49, s24, 1
  s_lshl_b32 s49, s49, 8
  s_add_u32 s48, s48, s49
  s_add_u32 s48, s48, 32768
  v_add_u32 v3, s48, v3
  s_lshl_b32 s48, s24, 1
  v_xor_b32 v4, s48, v1
  v_lshlrev_b32 v4, 4, v4
  s_mul_i32 s48, s24, 12288
  s_add_u32 s48, s48, 32768
  v_add_u32 v4, s48, v4
  s_mov_b32 s48, 43008
  v_mul_lo_u32 v5, v15, s48
  v_and_b32 v13, 7, v10
  v_mul_u32_u24 v13, 0xc0, v13
  v_add_u32 v5, v5, v13
  v_lshlrev_b32 v13, 4, v9
  v_add_u32 v5, v5, v13
  v_and_b32 v13, 1, v10
  v_lshlrev_b32 v13, 4, v13
  v_mov_b32 v14, 0x3f80
  v_lshlrev_b32 v0, v13, v14
  s_cmp_eq_u32 s61, 2
  s_cbranch_scc1 L_Shead
  s_waitcnt vmcnt(23)
  ds_write_b128 v7, v[112:115] offset:0
  s_waitcnt vmcnt(22)
  ds_write_b128 v7, v[116:119] offset:4096
  s_waitcnt vmcnt(21)
  ds_write_b128 v7, v[120:123] offset:8192
  s_waitcnt vmcnt(20)
  ds_write_b128 v7, v[124:127] offset:12288
  s_waitcnt vmcnt(19)
  ds_write_b128 v7, v[128:131] offset:16384
  s_waitcnt vmcnt(18)
  ds_write_b128 v7, v[132:135] offset:20480
  s_waitcnt vmcnt(17)
  ds_write_b128 v7, v[136:139] offset:24576
  s_waitcnt vmcnt(16)
  ds_write_b128 v7, v[140:143] offset:28672
  v_xor_b32 v8, 32, v2
  s_waitcnt vmcnt(4)
  ds_read_b128 v[16:19], v2 offset:0
  ds_read_b128 v[20:23], v8 offset:0
  ds_read_b128 v[24:27], v2 offset:64
  ds_read_b128 v[28:31], v8 offset:64
  ds_read_b128 v[32:35], v2 offset:128
  ds_read_b128 v[36:39], v8 offset:128
  ds_read_b128 v[40:43], v2 offset:1536
  ds_read_b128 v[44:47], v8 offset:1536
  ds_read_b128 v[48:51], v2 offset:1600
  ds_read_b128 v[52:55], v8 offset:1600
  ds_read_b128 v[56:59], v2 offset:1664
  ds_read_b128 v[60:63], v8 offset:1664
  s_waitcnt lgkmcnt(0)
  s_barrier
  v_mov_b32 v208, 0
  v_mov_b32 v209, 0
  v_mov_b32 v210, 0
  v_mov_b32 v211, 0
  v_mov_b32 v216, 0
  v_mov_b32 v217, 0
  v_mov_b32 v218, 0
  v_mov_b32 v219, 0
  v_dot2c_f32_bf16 v208, s30, v16
  v_dot2c_f32_bf16 v210, v16, v16
  v_dot2c_f32_bf16 v209, s30, v17
  v_dot2c_f32_bf16 v211, v17, v17
  v_dot2c_f32_bf16 v216, s30, v40
  v_dot2c_f32_bf16 v218, v40, v40
  v_dot2c_f32_bf16 v217, s30, v41
  v_dot2c_f32_bf16 v219, v41, v41
  v_dot2c_f32_bf16 v208, s30, v18
  v_dot2c_f32_bf16 v210, v18, v18
  v_dot2c_f32_bf16 v209, s30, v19
  v_dot2c_f32_bf16 v211, v19, v19
  v_dot2c_f32_bf16 v216, s30, v42
  v_dot2c_f32_bf16 v218, v42, v42
  v_dot2c_f32_bf16 v217, s30, v43
  v_dot2c_f32_bf16 v219, v43, v43
  v_dot2c_f32_bf16 v208, s30, v20
  v_dot2c_f32_bf16 v210, v20, v20
  v_dot2c_f32_bf16 v209, s30, v21
  v_dot2c_f32_bf16 v211, v21, v21
  v_dot2c_f32_bf16 v216, s30, v44
  v_dot2c_f32_bf16 v218, v44, v44
  v_dot2c_f32_bf16 v217, s30, v45
  v_dot2c_f32_bf16 v219, v45, v45
  v_dot2c_f32_bf16 v208, s30, v22
  v_dot2c_f32_bf16 v210, v22, v22
  v_dot2c_f32_bf16 v209, s30, v23
  v_dot2c_f32_bf16 v211, v23, v23
  v_dot2c_f32_bf16 v216, s30, v46
  v_dot2c_f32_bf16 v218, v46, v46
  v_dot2c_f32_bf16 v217, s30, v47
  v_dot2c_f32_bf16 v219, v47, v47
  v_dot2c_f32_bf16 v208, s30, v24
  v_dot2c_f32_bf16 v210, v24, v24
  v_dot2c_f32_bf16 v209, s30, v25
  v_dot2c_f32_bf16 v211, v25, v25
  v_dot2c_f32_bf16 v216, s30, v48
  v_dot2c_f32_bf16 v218, v48, v48
  v_dot2c_f32_bf16 v217, s30, v49
  v_dot2c_f32_bf16 v219, v49, v49
  v_dot2c_f32_bf16 v208, s30, v26
  v_dot2c_f32_bf16 v210, v26, v26
  v_dot2c_f32_bf16 v209, s30, v27
  v_dot2c_f32_bf16 v211, v27, v27
  v_dot2c_f32_bf16 v216, s30, v50
  v_dot2c_f32_bf16 v218, v50, v50
  v_dot2c_f32_bf16 v217, s30, v51
  v_dot2c_f32_bf16 v219, v51, v51
  v_dot2c_f32_bf16 v208, s30, v28
  v_dot2c_f32_bf16 v210, v28, v28
  v_dot2c_f32_bf16 v209, s30, v29
  v_dot2c_f32_bf16 v211, v29, v29
  v_dot2c_f32_bf16 v216, s30, v52
  v_dot2c_f32_bf16 v218, v52, v52
  v_dot2c_f32_bf16 v217, s30, v53
  v_dot2c_f32_bf16 v219, v53, v53
  v_dot2c_f32_bf16 v208, s30, v30
  v_dot2c_f32_bf16 v210, v30, v30
  v_dot2c_f32_bf16 v209, s30, v31
  v_dot2c_f32_bf16 v211, v31, v31
  v_dot2c_f32_bf16 v216, s30, v54
  v_dot2c_f32_bf16 v218, v54, v54
  v_dot2c_f32_bf16 v217, s30, v55
  v_dot2c_f32_bf16 v219, v55, v55
  v_dot2c_f32_bf16 v208, s30, v32
  v_dot2c_f32_bf16 v210, v32, v32
  v_dot2c_f32_bf16 v209, s30, v33
  v_dot2c_f32_bf16 v211, v33, v33
  v_dot2c_f32_bf16 v216, s30, v56
  v_dot2c_f32_bf16 v218, v56, v56
  v_dot2c_f32_bf16 v217, s30, v57
  v_dot2c_f32_bf16 v219, v57, v57
  v_dot2c_f32_bf16 v208, s30, v34
  v_dot2c_f32_bf16 v210, v34, v34
  v_dot2c_f32_bf16 v209, s30, v35
  v_dot2c_f32_bf16 v211, v35, v35
  v_dot2c_f32_bf16 v216, s30, v58
  v_dot2c_f32_bf16 v218, v58, v58
  v_dot2c_f32_bf16 v217, s30, v59
  v_dot2c_f32_bf16 v219, v59, v59
  v_dot2c_f32_bf16 v208, s30, v36
  v_dot2c_f32_bf16 v210, v36, v36
  v_dot2c_f32_bf16 v209, s30, v37
  v_dot2c_f32_bf16 v211, v37, v37
  v_dot2c_f32_bf16 v216, s30, v60
  v_dot2c_f32_bf16 v218, v60, v60
  v_dot2c_f32_bf16 v217, s30, v61
  v_dot2c_f32_bf16 v219, v61, v61
  v_dot2c_f32_bf16 v208, s30, v38
  v_dot2c_f32_bf16 v210, v38, v38
  v_dot2c_f32_bf16 v209, s30, v39
  v_dot2c_f32_bf16 v211, v39, v39
  v_dot2c_f32_bf16 v216, s30, v62
  v_dot2c_f32_bf16 v218, v62, v62
  v_dot2c_f32_bf16 v217, s30, v63
  v_dot2c_f32_bf16 v219, v63, v63
  v_add_f32 v208, v208, v209
  v_add_f32 v210, v210, v211
  v_add_f32 v216, v216, v217
  v_add_f32 v218, v218, v219
  v_permlane32_swap_b32 v208, v210
  v_lshlrev_b32 v224, 16, v16
  v_permlane32_swap_b32 v216, v218
  v_add_f32 v208, v208, v210
  v_add_f32 v216, v216, v218
  v_mov_b32 v210, v208
  v_mov_b32 v218, v216
  v_and_b32 v225, s31, v16
  v_permlane32_swap_b32 v208, v210
  v_permlane32_swap_b32 v216, v218
  v_mul_f32 v208, 0x3c2aaaab, v208
  v_mul_f32 v210, 0x3c2aaaab, v210
  v_mul_f32 v216, 0x3c2aaaab, v216
  v_mul_f32 v218, 0x3c2aaaab, v218
  v_fma_f32 v210, -v208, v208, v210
  v_fma_f32 v218, -v216, v216, v218
  v_max_f32 v210, 0, v210
  v_max_f32 v218, 0, v218
  v_add_f32 v210, 0x3727c5ac, v210
  v_add_f32 v218, 0x3727c5ac, v218
  v_rsq_f32 v212, v210
  v_rsq_f32 v220, v218
  v_mul_f32 v213, -v208, v212
  v_mul_f32 v221, -v216, v220
  v_lshlrev_b32 v226, 16, v17
  v_and_b32 v227, s31, v17
  v_lshlrev_b32 v228, 16, v18
  v_and_b32 v229, s31, v18
  v_lshlrev_b32 v230, 16, v19
  v_and_b32 v231, s31, v19
  v_lshlrev_b32 v232, 16, v40
  v_and_b32 v233, s31, v40
  v_lshlrev_b32 v234, 16, v41
  v_and_b32 v235, s31, v41
  v_lshlrev_b32 v236, 16, v42
  v_and_b32 v237, s31, v42
  v_lshlrev_b32 v238, 16, v43
  v_and_b32 v239, s31, v43
  v_fma_f32 v224, v224, v212, v213
  v_fma_f32 v225, v225, v212, v213
  v_fma_f32 v226, v226, v212, v213
  v_fma_f32 v227, v227, v212, v213
  v_fma_f32 v228, v228, v212, v213
  v_fma_f32 v229, v229, v212, v213
  v_fma_f32 v230, v230, v212, v213
  v_fma_f32 v231, v231, v212, v213
  v_fma_f32 v232, v232, v220, v221
  v_fma_f32 v233, v233, v220, v221
  v_fma_f32 v234, v234, v220, v221
  v_fma_f32 v235, v235, v220, v221
  v_fma_f32 v236, v236, v220, v221
  v_fma_f32 v237, v237, v220, v221
  v_fma_f32 v238, v238, v220, v221
  v_fma_f32 v239, v239, v220, v221
  v_cvt_pk_bf16_f32 v64, v224, v225
  v_cvt_pk_bf16_f32 v65, v226, v227
  v_cvt_pk_bf16_f32 v66, v228, v229
  v_cvt_pk_bf16_f32 v67, v230, v231
  v_cvt_pk_bf16_f32 v88, v232, v233
  v_cvt_pk_bf16_f32 v89, v234, v235
  s_waitcnt vmcnt(3)
  v_mfma_f32_32x32x16_bf16 v[112:127], v[240:243], v[64:67], 0
  v_cvt_pk_bf16_f32 v90, v236, v237
  v_cvt_pk_bf16_f32 v91, v238, v239
  v_lshlrev_b32 v224, 16, v20
  v_and_b32 v225, s31, v20
  v_lshlrev_b32 v226, 16, v21
  v_and_b32 v227, s31, v21
  v_mfma_f32_32x32x16_bf16 v[128:143], v[240:243], v[88:91], 0
  ds_read_b128 v[240:243], v6 offset:0
  v_lshlrev_b32 v228, 16, v22
  v_and_b32 v229, s31, v22
  v_lshlrev_b32 v230, 16, v23
  v_and_b32 v231, s31, v23
  v_lshlrev_b32 v232, 16, v44
  s_waitcnt vmcnt(2)
  v_mfma_f32_32x32x16_bf16 v[144:159], v[244:247], v[64:67], 0
  v_and_b32 v233, s31, v44
  v_lshlrev_b32 v234, 16, v45
  v_and_b32 v235, s31, v45
  v_lshlrev_b32 v236, 16, v46
  v_and_b32 v237, s31, v46
  v_lshlrev_b32 v238, 16, v47
  v_mfma_f32_32x32x16_bf16 v[160:175], v[244:247], v[88:91], 0
  ds_read_b128 v[244:247], v6 offset:1024
  v_and_b32 v239, s31, v47
  v_fma_f32 v224, v224, v212, v213
  v_fma_f32 v225, v225, v212, v213
  v_fma_f32 v226, v226, v212, v213
  v_fma_f32 v227, v227, v212, v213
  s_waitcnt vmcnt(1)
  v_mfma_f32_32x32x16_bf16 v[176:191], v[248:251], v[64:67], 0
  v_fma_f32 v228, v228, v212, v213
  v_fma_f32 v229, v229, v212, v213
  v_fma_f32 v230, v230, v212, v213
  v_fma_f32 v231, v231, v212, v213
  v_fma_f32 v232, v232, v220, v221
  v_fma_f32 v233, v233, v220, v221
  v_mfma_f32_32x32x16_bf16 v[192:207], v[248:251], v[88:91], 0
  v_fma_f32 v234, v234, v220, v221
  v_fma_f32 v235, v235, v220, v221
  v_fma_f32 v236, v236, v220, v221
  v_fma_f32 v237, v237, v220, v221
  v_fma_f32 v238, v238, v220, v221
  v_fma_f32 v239, v239, v220, v221
  ds_read_b128 v[248:251], v6 offset:2048
  v_cvt_pk_bf16_f32 v68, v224, v225
  v_cvt_pk_bf16_f32 v69, v226, v227
  v_cvt_pk_bf16_f32 v70, v228, v229
  v_cvt_pk_bf16_f32 v71, v230, v231
  v_cvt_pk_bf16_f32 v92, v232, v233
  v_cvt_pk_bf16_f32 v93, v234, v235
  s_waitcnt vmcnt(0)
  v_mfma_f32_32x32x16_bf16 v[112:127], v[252:255], v[68:71], v[112:127]
  v_cvt_pk_bf16_f32 v94, v236, v237
  v_cvt_pk_bf16_f32 v95, v238, v239
  v_lshlrev_b32 v224, 16, v24
  v_and_b32 v225, s31, v24
  v_lshlrev_b32 v226, 16, v25
  v_and_b32 v227, s31, v25
  v_mfma_f32_32x32x16_bf16 v[128:143], v[252:255], v[92:95], v[128:143]
  ds_read_b128 v[252:255], v6 offset:3072
  v_lshlrev_b32 v228, 16, v26
  v_and_b32 v229, s31, v26
  v_lshlrev_b32 v230, 16, v27
  v_and_b32 v231, s31, v27
  v_lshlrev_b32 v232, 16, v48
  s_waitcnt lgkmcnt(3)
  v_mfma_f32_32x32x16_bf16 v[144:159], v[240:243], v[68:71], v[144:159]
  v_and_b32 v233, s31, v48
  v_lshlrev_b32 v234, 16, v49
  v_and_b32 v235, s31, v49
  v_lshlrev_b32 v236, 16, v50
  v_and_b32 v237, s31, v50
  v_lshlrev_b32 v238, 16, v51
  v_mfma_f32_32x32x16_bf16 v[160:175], v[240:243], v[92:95], v[160:175]
  ds_read_b128 v[240:243], v6 offset:4096
  v_and_b32 v239, s31, v51
  v_fma_f32 v224, v224, v212, v213
  v_fma_f32 v225, v225, v212, v213
  v_fma_f32 v226, v226, v212, v213
  v_fma_f32 v227, v227, v212, v213
  s_waitcnt lgkmcnt(3)
  v_mfma_f32_32x32x16_bf16 v[176:191], v[244:247], v[68:71], v[176:191]
  v_fma_f32 v228, v228, v212, v213
  v_fma_f32 v229, v229, v212, v213
  v_fma_f32 v230, v230, v212, v213
  v_fma_f32 v231, v231, v212, v213
  v_fma_f32 v232, v232, v220, v221
  v_fma_f32 v233, v233, v220, v221
  v_mfma_f32_32x32x16_bf16 v[192:207], v[244:247], v[92:95], v[192:207]
  v_fma_f32 v234, v234, v220, v221
  v_fma_f32 v235, v235, v220, v221
  v_fma_f32 v236, v236, v220, v221
  v_fma_f32 v237, v237, v220, v221
  v_fma_f32 v238, v238, v220, v221
  v_fma_f32 v239, v239, v220, v221
  ds_read_b128 v[244:247], v6 offset:5120
  v_cvt_pk_bf16_f32 v72, v224, v225
  v_cvt_pk_bf16_f32 v73, v226, v227
  v_cvt_pk_bf16_f32 v74, v228, v229
  v_cvt_pk_bf16_f32 v75, v230, v231
  v_cvt_pk_bf16_f32 v96, v232, v233
  v_cvt_pk_bf16_f32 v97, v234, v235
  s_waitcnt lgkmcnt(3)
  v_mfma_f32_32x32x16_bf16 v[112:127], v[248:251], v[72:75], v[112:127]
  v_cvt_pk_bf16_f32 v98, v236, v237
  v_cvt_pk_bf16_f32 v99, v238, v239
  v_lshlrev_b32 v224, 16, v28
  v_and_b32 v225, s31, v28
  v_lshlrev_b32 v226, 16, v29
  v_and_b32 v227, s31, v29
  v_mfma_f32_32x32x16_bf16 v[128:143], v[248:251], v[96:99], v[128:143]
  ds_read_b128 v[248:251], v6 offset:6144
  v_lshlrev_b32 v228, 16, v30
  v_and_b32 v229, s31, v30
  v_lshlrev_b32 v230, 16, v31
  v_and_b32 v231, s31, v31
  v_lshlrev_b32 v232, 16, v52
  s_waitcnt lgkmcnt(3)
  v_mfma_f32_32x32x16_bf16 v[144:159], v[252:255], v[72:75], v[144:159]
  v_and_b32 v233, s31, v52
  v_lshlrev_b32 v234, 16, v53
  v_and_b32 v235, s31, v53
  v_lshlrev_b32 v236, 16, v54
  v_and_b32 v237, s31, v54
  v_lshlrev_b32 v238, 16, v55
  v_mfma_f32_32x32x16_bf16 v[160:175], v[252:255], v[96:99], v[160:175]
  ds_read_b128 v[252:255], v6 offset:7168
  v_and_b32 v239, s31, v55
  v_fma_f32 v224, v224, v212, v213
  v_fma_f32 v225, v225, v212, v213
  v_fma_f32 v226, v226, v212, v213
  v_fma_f32 v227, v227, v212, v213
  s_waitcnt lgkmcnt(3)
  v_mfma_f32_32x32x16_bf16 v[176:191], v[240:243], v[72:75], v[176:191]
  v_fma_f32 v228, v228, v212, v213
  v_fma_f32 v229, v229, v212, v213
  v_fma_f32 v230, v230, v212, v213
  v_fma_f32 v231, v231, v212, v213
  v_fma_f32 v232, v232, v220, v221
  v_fma_f32 v233, v233, v220, v221
  v_mfma_f32_32x32x16_bf16 v[192:207], v[240:243], v[96:99], v[192:207]
  ds_read_b128 v[240:243], v6 offset:8192
  v_fma_f32 v234, v234, v220, v221
  v_fma_f32 v235, v235, v220, v221
  v_fma_f32 v236, v236, v220, v221
  v_fma_f32 v237, v237, v220, v221
  v_fma_f32 v238, v238, v220, v221
  v_fma_f32 v239, v239, v220, v221
  v_cvt_pk_bf16_f32 v76, v224, v225
  v_cvt_pk_bf16_f32 v77, v226, v227
  v_cvt_pk_bf16_f32 v78, v228, v229
  v_cvt_pk_bf16_f32 v79, v230, v231
  v_cvt_pk_bf16_f32 v100, v232, v233
  v_cvt_pk_bf16_f32 v101, v234, v235
  s_waitcnt lgkmcnt(3)
  v_mfma_f32_32x32x16_bf16 v[112:127], v[244:247], v[76:79], v[112:127]
  v_cvt_pk_bf16_f32 v102, v236, v237
  v_cvt_pk_bf16_f32 v103, v238, v239
  v_lshlrev_b32 v224, 16, v32
  v_and_b32 v225, s31, v32
  v_lshlrev_b32 v226, 16, v33
  v_and_b32 v227, s31, v33
  v_mfma_f32_32x32x16_bf16 v[128:143], v[244:247], v[100:103], v[128:143]
  ds_read_b128 v[244:247], v6 offset:9216
  v_lshlrev_b32 v228, 16, v34
  v_and_b32 v229, s31, v34
  v_lshlrev_b32 v230, 16, v35
  v_and_b32 v231, s31, v35
  v_lshlrev_b32 v232, 16, v56
  s_waitcnt lgkmcnt(3)
  v_mfma_f32_32x32x16_bf16 v[144:159], v[248:251], v[76:79], v[144:159]
  v_and_b32 v233, s31, v56
  v_lshlrev_b32 v234, 16, v57
  v_and_b32 v235, s31, v57
  v_lshlrev_b32 v236, 16, v58
  v_and_b32 v237, s31, v58
  v_lshlrev_b32 v238, 16, v59
  v_mfma_f32_32x32x16_bf16 v[160:175], v[248:251], v[100:103], v[160:175]
  v_and_b32 v239, s31, v59
  ds_read_b128 v[248:251], v6 offset:10240
  v_fma_f32 v224, v224, v212, v213
  v_fma_f32 v225, v225, v212, v213
  v_fma_f32 v226, v226, v212, v213
  v_fma_f32 v227, v227, v212, v213
  s_waitcnt lgkmcnt(3)
  v_mfma_f32_32x32x16_bf16 v[176:191], v[252:255], v[76:79], v[176:191]
  v_fma_f32 v228, v228, v212, v213
  v_fma_f32 v229, v229, v212, v213
  v_fma_f32 v230, v230, v212, v213
  v_fma_f32 v231, v231, v212, v213
  v_fma_f32 v232, v232, v220, v221
  v_fma_f32 v233, v233, v220, v221
  v_mfma_f32_32x32x16_bf16 v[192:207], v[252:255], v[100:103], v[192:207]
  v_fma_f32 v234, v234, v220, v221
  v_fma_f32 v235, v235, v220, v221
  v_fma_f32 v236, v236, v220, v221
  v_fma_f32 v237, v237, v220, v221
  v_fma_f32 v238, v238, v220, v221
  v_fma_f32 v239, v239, v220, v221
  v_cvt_pk_bf16_f32 v80, v224, v225
  v_cvt_pk_bf16_f32 v81, v226, v227
  v_cvt_pk_bf16_f32 v82, v228, v229
  v_cvt_pk_bf16_f32 v83, v230, v231
  v_cvt_pk_bf16_f32 v104, v232, v233
  v_cvt_pk_bf16_f32 v105, v234, v235
  s_waitcnt lgkmcnt(2)
  v_mfma_f32_32x32x16_bf16 v[112:127], v[240:243], v[80:83], v[112:127]
  v_cvt_pk_bf16_f32 v106, v236, v237
  v_cvt_pk_bf16_f32 v107, v238, v239
  ds_read_b128 v[252:255], v6 offset:11264
  v_lshlrev_b32 v224, 16, v36
  v_and_b32 v225, s31, v36
  v_lshlrev_b32 v226, 16, v37
  v_mfma_f32_32x32x16_bf16 v[128:143], v[240:243], v[104:107], v[128:143]
  ds_read_b128 v[240:243], v6 offset:12288
  v_and_b32 v227, s31, v37
  v_lshlrev_b32 v228, 16, v38
  v_and_b32 v229, s31, v38
  v_lshlrev_b32 v230, 16, v39
  v_and_b32 v231, s31, v39
  s_waitcnt lgkmcnt(3)
  v_mfma_f32_32x32x16_bf16 v[144:159], v[244:247], v[80:83], v[144:159]
  v_lshlrev_b32 v232, 16, v60
  v_and_b32 v233, s31, v60
  v_lshlrev_b32 v234, 16, v61
  v_and_b32 v235, s31, v61
  v_lshlrev_b32 v236, 16, v62
  v_and_b32 v237, s31, v62
  v_mfma_f32_32x32x16_bf16 v[160:175], v[244:247], v[104:107], v[160:175]
  ds_read_b128 v[244:247], v6 offset:13312
  v_lshlrev_b32 v238, 16, v63
  v_and_b32 v239, s31, v63
  v_fma_f32 v224, v224, v212, v213
  v_fma_f32 v225, v225, v212, v213
  v_fma_f32 v226, v226, v212, v213
  s_waitcnt lgkmcnt(3)
  v_mfma_f32_32x32x16_bf16 v[176:191], v[248:251], v[80:83], v[176:191]
  v_fma_f32 v227, v227, v212, v213
  v_fma_f32 v228, v228, v212, v213
  v_fma_f32 v229, v229, v212, v213
  v_fma_f32 v230, v230, v212, v213
  v_fma_f32 v231, v231, v212, v213
  v_fma_f32 v232, v232, v220, v221
  v_mfma_f32_32x32x16_bf16 v[192:207], v[248:251], v[104:107], v[192:207]
  v_fma_f32 v233, v233, v220, v221
  v_fma_f32 v234, v234, v220, v221
  v_fma_f32 v235, v235, v220, v221
  v_fma_f32 v236, v236, v220, v221
  v_fma_f32 v237, v237, v220, v221
  v_fma_f32 v238, v238, v220, v221
  v_fma_f32 v239, v239, v220, v221
  ds_read_b128 v[248:251], v6 offset:14336
  v_cvt_pk_bf16_f32 v84, v224, v225
  v_cvt_pk_bf16_f32 v85, v226, v227
  v_cvt_pk_bf16_f32 v86, v228, v229
  v_cvt_pk_bf16_f32 v87, v230, v231
  v_cvt_pk_bf16_f32 v108, v232, v233
  v_cvt_pk_bf16_f32 v109, v234, v235
  s_waitcnt lgkmcnt(3)
  v_mfma_f32_32x32x16_bf16 v[112:127], v[252:255], v[84:87], v[112:127]
  v_cvt_pk_bf16_f32 v110, v236, v237
  v_cvt_pk_bf16_f32 v111, v238, v239
  s_nop 0
  s_nop 0
  v_mfma_f32_32x32x16_bf16 v[128:143], v[252:255], v[108:111], v[128:143]
  ds_read_b128 v[252:255], v6 offset:15360
  s_waitcnt lgkmcnt(3)
  v_mfma_f32_32x32x16_bf16 v[144:159], v[240:243], v[84:87], v[144:159]
  s_nop 3
  v_cvt_pk_bf16_f32 v112, v112, v113
  v_cvt_pk_bf16_f32 v113, v114, v115
  v_cvt_pk_bf16_f32 v114, v116, v117
  v_cvt_pk_bf16_f32 v115, v118, v119
  v_cvt_pk_bf16_f32 v116, v120, v121
  v_cvt_pk_bf16_f32 v117, v122, v123
  v_mfma_f32_32x32x16_bf16 v[160:175], v[240:243], v[108:111], v[160:175]
  ds_read_b128 v[240:243], v6 offset:16384
  v_cvt_pk_bf16_f32 v118, v124, v125
  v_cvt_pk_bf16_f32 v119, v126, v127
  v_cvt_pk_bf16_f32 v120, v128, v129
  v_cvt_pk_bf16_f32 v121, v130, v131
  v_cvt_pk_bf16_f32 v122, v132, v133
  s_waitcnt lgkmcnt(3)
  v_mfma_f32_32x32x16_bf16 v[176:191], v[244:247], v[84:87], v[176:191]
  v_cvt_pk_bf16_f32 v144, v144, v145
  v_cvt_pk_bf16_f32 v145, v146, v147
  v_cvt_pk_bf16_f32 v146, v148, v149
  v_cvt_pk_bf16_f32 v147, v150, v151
  v_cvt_pk_bf16_f32 v148, v152, v153
  v_cvt_pk_bf16_f32 v149, v154, v155
  v_mfma_f32_32x32x16_bf16 v[192:207], v[244:247], v[108:111], v[192:207]
  ds_read_b128 v[244:247], v6 offset:17408
  v_cvt_pk_bf16_f32 v150, v156, v157
  v_cvt_pk_bf16_f32 v151, v158, v159
  v_cvt_pk_bf16_f32 v123, v134, v135
  v_cvt_pk_bf16_f32 v124, v136, v137
  v_cvt_pk_bf16_f32 v125, v138, v139
  v_mfma_f32_32x32x16_bf16 v[208:223], v[88:91], v[120:123], 0
  v_cvt_pk_bf16_f32 v126, v140, v141
  v_cvt_pk_bf16_f32 v127, v142, v143
  v_cvt_pk_bf16_f32 v152, v160, v161
  v_cvt_pk_bf16_f32 v153, v162, v163
  v_cvt_pk_bf16_f32 v154, v164, v165
  v_cvt_pk_bf16_f32 v155, v166, v167
  s_waitcnt lgkmcnt(3)
  v_mfma_f32_32x32x16_bf16 v[128:143], v[64:67], v[248:251], 0
  v_cvt_pk_bf16_f32 v156, v168, v169
  v_cvt_pk_bf16_f32 v157, v170, v171
  v_cvt_pk_bf16_f32 v158, v172, v173
  v_cvt_pk_bf16_f32 v159, v174, v175
  v_cvt_pk_bf16_f32 v176, v176, v177
  v_cvt_pk_bf16_f32 v177, v178, v179
  v_mfma_f32_32x32x16_bf16 v[160:175], v[88:91], v[248:251], 0
  ds_read_b128 v[248:251], v6 offset:18432
  v_cvt_pk_bf16_f32 v178, v180, v181
  v_cvt_pk_bf16_f32 v179, v182, v183
  v_cvt_pk_bf16_f32 v180, v184, v185
  v_cvt_pk_bf16_f32 v181, v186, v187
  v_cvt_pk_bf16_f32 v182, v188, v189
  s_waitcnt lgkmcnt(3)
  v_mfma_f32_32x32x16_bf16 v[128:143], v[68:71], v[252:255], v[128:143]
  v_cvt_pk_bf16_f32 v183, v190, v191
  v_cvt_pk_bf16_f32 v184, v192, v193
  v_cvt_pk_bf16_f32 v185, v194, v195
  v_cvt_pk_bf16_f32 v186, v196, v197
  v_cvt_pk_bf16_f32 v187, v198, v199
  v_cvt_pk_bf16_f32 v188, v200, v201
  v_mfma_f32_32x32x16_bf16 v[160:175], v[92:95], v[252:255], v[160:175]
  ds_read_b128 v[252:255], v6 offset:19456
  v_cvt_pk_bf16_f32 v189, v202, v203
  v_cvt_pk_bf16_f32 v190, v204, v205
  v_cvt_pk_bf16_f32 v191, v206, v207
  s_waitcnt lgkmcnt(3)
  v_mfma_f32_32x32x16_bf16 v[128:143], v[72:75], v[240:243], v[128:143]
  v_mfma_f32_32x32x16_bf16 v[160:175], v[96:99], v[240:243], v[160:175]
  ds_read_b128 v[240:243], v6 offset:20480
  s_waitcnt lgkmcnt(3)
  v_mfma_f32_32x32x16_bf16 v[128:143], v[76:79], v[244:247], v[128:143]
  v_mfma_f32_32x32x16_bf16 v[192:207], v[64:67], v[112:115], 0
  v_mfma_f32_32x32x16_bf16 v[160:175], v[100:103], v[244:247], v[160:175]
  ds_read_b128 v[244:247], v6 offset:21504
  s_waitcnt lgkmcnt(3)
  v_mfma_f32_32x32x16_bf16 v[128:143], v[80:83], v[248:251], v[128:143]
  v_mfma_f32_32x32x16_bf16 v[192:207], v[68:71], v[116:119], v[192:207]
  v_mfma_f32_32x32x16_bf16 v[160:175], v[104:107], v[248:251], v[160:175]
  ds_read_b128 v[248:251], v6 offset:22528
  s_waitcnt lgkmcnt(3)
  v_mfma_f32_32x32x16_bf16 v[128:143], v[84:87], v[252:255], v[128:143]
  v_mfma_f32_32x32x16_bf16 v[192:207], v[72:75], v[144:147], v[192:207]
  v_mfma_f32_32x32x16_bf16 v[160:175], v[108:111], v[252:255], v[160:175]
  s_nop 9
  v_cvt_pk_bf16_f32 v128, v128, v129
  v_cvt_pk_bf16_f32 v129, v130, v131
  v_cvt_pk_bf16_f32 v130, v132, v133
  v_cvt_pk_bf16_f32 v131, v134, v135
  ds_read_b128 v[252:255], v6 offset:23552
  v_cvt_pk_bf16_f32 v132, v136, v137
  v_mfma_f32_32x32x16_bf16 v[192:207], v[76:79], v[148:151], v[192:207]
  v_cvt_pk_bf16_f32 v133, v138, v139
  v_cvt_pk_bf16_f32 v134, v140, v141
  v_cvt_pk_bf16_f32 v135, v142, v143
  v_mfma_f32_32x32x16_bf16 v[192:207], v[80:83], v[176:179], v[192:207]
  v_cvt_pk_bf16_f32 v136, v160, v161
  v_cvt_pk_bf16_f32 v137, v162, v163
  v_cvt_pk_bf16_f32 v138, v164, v165
  v_cvt_pk_bf16_f32 v139, v166, v167
  v_cvt_pk_bf16_f32 v140, v168, v169
  v_cvt_pk_bf16_f32 v141, v170, v171
  s_waitcnt lgkmcnt(3)
  v_mfma_f32_32x32x16_bf16 v[224:239], v[64:67], v[240:243], 0
  v_cvt_pk_bf16_f32 v142, v172, v173
  v_cvt_pk_bf16_f32 v143, v174, v175
  v_mfma_f32_32x32x16_bf16 v[160:175], v[88:91], v[240:243], 0
  ds_read_b128 v[240:243], v6 offset:24576
  v_mfma_f32_32x32x16_bf16 v[208:223], v[92:95], v[124:127], v[208:223]
  v_mfma_f32_32x32x16_bf16 v[192:207], v[84:87], v[180:183], v[192:207]
  s_waitcnt lgkmcnt(3)
  v_mfma_f32_32x32x16_bf16 v[224:239], v[68:71], v[244:247], v[224:239]
  v_mfma_f32_32x32x16_bf16 v[160:175], v[92:95], v[244:247], v[160:175]
  ds_read_b128 v[244:247], v6 offset:25600
  s_nop 7
  v_cndmask_b32 v8, v192, v196, s[32:33]
  v_cndmask_b32 v9, v193, v197, s[32:33]
  v_cndmask_b32 v10, v194, v198, s[32:33]
  v_cndmask_b32 v8, v8, v200, s[34:35]
  v_cndmask_b32 v9, v9, v201, s[34:35]
  v_mfma_f32_32x32x16_bf16 v[208:223], v[96:99], v[152:155], v[208:223]
  v_cndmask_b32 v10, v10, v202, s[34:35]
  v_cndmask_b32 v11, v195, v199, s[32:33]
  v_cndmask_b32 v8, v8, v204, s[36:37]
  v_cndmask_b32 v9, v9, v205, s[36:37]
  v_cndmask_b32 v10, v10, v206, s[36:37]
  v_cndmask_b32 v11, v11, v203, s[34:35]
  s_waitcnt lgkmcnt(3)
  v_mfma_f32_32x32x16_bf16 v[224:239], v[72:75], v[248:251], v[224:239]
  v_cndmask_b32 v11, v11, v207, s[36:37]
  v_max3_f32 v12, v8, v9, v10
  v_lshlrev_b32 v192, 16, v16
  v_max_f32 v12, v12, v11
  v_and_b32 v193, s31, v16
  v_sub_f32 v8, v8, v12
  v_mfma_f32_32x32x16_bf16 v[160:175], v[96:99], v[248:251], v[160:175]
  ds_read_b128 v[248:251], v6 offset:26624
  v_sub_f32 v9, v9, v12
  v_sub_f32 v10, v10, v12
  v_sub_f32 v11, v11, v12
  v_exp_f32 v8, v8
  v_mfma_f32_32x32x16_bf16 v[208:223], v[100:103], v[156:159], v[208:223]
  v_exp_f32 v9, v9
  v_exp_f32 v10, v10
  v_exp_f32 v11, v11
  s_waitcnt lgkmcnt(3)
  v_mfma_f32_32x32x16_bf16 v[224:239], v[76:79], v[252:255], v[224:239]
  v_add_f32 v13, v8, v9
  v_add_f32 v12, v10, v11
  v_lshlrev_b32 v194, 16, v17
  v_add_f32 v13, v13, v12
  v_and_b32 v195, s31, v17
  v_rcp_f32 v13, v13
  v_mfma_f32_32x32x16_bf16 v[160:175], v[100:103], v[252:255], v[160:175]
  ds_read_b128 v[252:255], v6 offset:27648
  v_mul_f32 v8, v8, v13
  v_mul_f32 v9, v9, v13
  v_mul_f32 v10, v10, v13
  v_mul_f32 v11, v11, v13
  v_cvt_pk_bf16_f32 v8, v8, v9
  v_mfma_f32_32x32x16_bf16 v[208:223], v[104:107], v[184:187], v[208:223]
  v_cvt_pk_bf16_f32 v9, v10, v11
  v_cndmask_b32 v176, 0, v8, s[38:39]
  v_cndmask_b32 v177, 0, v9, s[38:39]
  v_cndmask_b32 v178, 0, v8, s[40:41]
  v_cndmask_b32 v179, 0, v9, s[40:41]
  v_cndmask_b32 v180, 0, v8, s[42:43]
  s_waitcnt lgkmcnt(3)
  v_mfma_f32_32x32x16_bf16 v[224:239], v[80:83], v[240:243], v[224:239]
  v_cndmask_b32 v181, 0, v9, s[42:43]
  v_cndmask_b32 v182, 0, v8, s[44:45]
  v_cndmask_b32 v183, 0, v9, s[44:45]
  v_lshlrev_b32 v196, 16, v18
  v_and_b32 v197, s31, v18
  v_lshlrev_b32 v198, 16, v19
  v_mfma_f32_32x32x16_bf16 v[160:175], v[104:107], v[240:243], v[160:175]
  ds_read_b128 v[240:243], v6 offset:28672
  v_and_b32 v199, s31, v19
  v_lshlrev_b32 v200, 16, v20
  v_and_b32 v201, s31, v20
  v_lshlrev_b32 v202, 16, v21
  v_and_b32 v203, s31, v21
  v_mfma_f32_32x32x16_bf16 v[208:223], v[108:111], v[188:191], v[208:223]
  v_lshlrev_b32 v204, 16, v22
  v_and_b32 v205, s31, v22
  v_lshlrev_b32 v206, 16, v23
  v_and_b32 v207, s31, v23
  s_waitcnt lgkmcnt(3)
  v_mfma_f32_32x32x16_bf16 v[224:239], v[84:87], v[244:247], v[224:239]
  v_mfma_f32_32x32x16_bf16 v[160:175], v[108:111], v[244:247], v[160:175]
  ds_read_b128 v[244:247], v6 offset:29696
  s_nop 3
  v_cndmask_b32 v8, v208, v212, s[32:33]
  v_cndmask_b32 v9, v209, v213, s[32:33]
  v_cndmask_b32 v10, v210, v214, s[32:33]
  v_cndmask_b32 v8, v8, v216, s[34:35]
  v_cndmask_b32 v9, v9, v217, s[34:35]
  s_waitcnt lgkmcnt(3)
  v_mfma_f32_32x32x16_bf16 v[112:127], v[64:67], v[248:251], 0
  v_cndmask_b32 v10, v10, v218, s[34:35]
  v_cndmask_b32 v11, v211, v215, s[32:33]
  v_cndmask_b32 v8, v8, v220, s[36:37]
  v_cndmask_b32 v9, v9, v221, s[36:37]
  v_cndmask_b32 v10, v10, v222, s[36:37]
  v_cndmask_b32 v11, v11, v219, s[34:35]
  v_mfma_f32_32x32x16_bf16 v[144:159], v[88:91], v[248:251], 0
  ds_read_b128 v[248:251], v6 offset:30720
  v_cndmask_b32 v11, v11, v223, s[36:37]
  v_max3_f32 v12, v8, v9, v10
  v_lshlrev_b32 v208, 16, v40
  v_max_f32 v12, v12, v11
  v_and_b32 v209, s31, v40
  s_waitcnt lgkmcnt(3)
  v_mfma_f32_32x32x16_bf16 v[112:127], v[68:71], v[252:255], v[112:127]
  v_sub_f32 v8, v8, v12
  v_sub_f32 v9, v9, v12
  v_sub_f32 v10, v10, v12
  v_sub_f32 v11, v11, v12
  v_exp_f32 v8, v8
  v_mfma_f32_32x32x16_bf16 v[144:159], v[92:95], v[252:255], v[144:159]
  v_exp_f32 v9, v9
  v_exp_f32 v10, v10
  v_exp_f32 v11, v11
  s_waitcnt lgkmcnt(2)
  v_mfma_f32_32x32x16_bf16 v[112:127], v[72:75], v[240:243], v[112:127]
  ds_read_b128 v[252:255], v6 offset:31744
  v_add_f32 v13, v8, v9
  v_add_f32 v12, v10, v11
  v_lshlrev_b32 v210, 16, v41
  v_add_f32 v13, v13, v12
  v_and_b32 v211, s31, v41
  v_mfma_f32_32x32x16_bf16 v[144:159], v[96:99], v[240:243], v[144:159]
  v_rcp_f32 v13, v13
  v_lshlrev_b32 v212, 16, v42
  v_mul_f32 v8, v8, v13
  v_mul_f32 v9, v9, v13
  v_mul_f32 v10, v10, v13
  s_waitcnt lgkmcnt(2)
  v_mfma_f32_32x32x16_bf16 v[112:127], v[76:79], v[244:247], v[112:127]
  v_mul_f32 v11, v11, v13
  v_cvt_pk_bf16_f32 v8, v8, v9
  v_cvt_pk_bf16_f32 v9, v10, v11
  v_cndmask_b32 v184, 0, v8, s[38:39]
  v_cndmask_b32 v185, 0, v9, s[38:39]
  v_cndmask_b32 v186, 0, v8, s[40:41]
  v_mfma_f32_32x32x16_bf16 v[192:207], v[128:131], v[176:179], v[192:207]
  v_cndmask_b32 v187, 0, v9, s[40:41]
  v_and_b32 v213, s31, v42
  v_lshlrev_b32 v214, 16, v43
  v_and_b32 v215, s31, v43
  v_lshlrev_b32 v216, 16, v44
  v_and_b32 v217, s31, v44
  v_mfma_f32_32x32x16_bf16 v[144:159], v[100:103], v[244:247], v[144:159]
  v_lshlrev_b32 v218, 16, v45
  v_and_b32 v219, s31, v45
  v_lshlrev_b32 v220, 16, v46
  v_and_b32 v221, s31, v46
  v_lshlrev_b32 v222, 16, v47
  v_and_b32 v223, s31, v47
  s_waitcnt lgkmcnt(1)
  v_mfma_f32_32x32x16_bf16 v[112:127], v[80:83], v[248:251], v[112:127]
  v_cndmask_b32 v188, 0, v8, s[42:43]
  v_cndmask_b32 v189, 0, v9, s[42:43]
  v_cndmask_b32 v190, 0, v8, s[44:45]
  v_cndmask_b32 v191, 0, v9, s[44:45]
  v_cvt_pk_bf16_f32 v224, v224, v225
  v_cvt_pk_bf16_f32 v225, v226, v227
  v_mfma_f32_32x32x16_bf16 v[208:223], v[136:139], v[184:187], v[208:223]
  v_cvt_pk_bf16_f32 v226, v228, v229
  v_cvt_pk_bf16_f32 v227, v230, v231
  v_cvt_pk_bf16_f32 v228, v232, v233
  v_cvt_pk_bf16_f32 v229, v234, v235
  v_cvt_pk_bf16_f32 v230, v236, v237
  v_cvt_pk_bf16_f32 v231, v238, v239
  v_mfma_f32_32x32x16_bf16 v[192:207], v[132:135], v[180:183], v[192:207]
  v_cvt_pk_bf16_f32 v232, v160, v161
  v_cvt_pk_bf16_f32 v233, v162, v163
  v_cvt_pk_bf16_f32 v234, v164, v165
  v_cvt_pk_bf16_f32 v235, v166, v167
  v_cvt_pk_bf16_f32 v236, v168, v169
  v_cvt_pk_bf16_f32 v237, v170, v171
  v_mfma_f32_32x32x16_bf16 v[208:223], v[140:143], v[188:191], v[208:223]
  v_cvt_pk_bf16_f32 v238, v172, v173
  v_cvt_pk_bf16_f32 v239, v174, v175
  v_lshlrev_b32 v160, 16, v24
  v_and_b32 v161, s31, v24
  v_lshlrev_b32 v162, 16, v25
  v_and_b32 v163, s31, v25
  v_mfma_f32_32x32x16_bf16 v[144:159], v[104:107], v[248:251], v[144:159]
  v_cvt_pk_bf16_f32 v192, v192, v193
  v_cvt_pk_bf16_f32 v193, v194, v195
  v_cvt_pk_bf16_f32 v194, v196, v197
  v_cvt_pk_bf16_f32 v195, v198, v199
  v_cvt_pk_bf16_f32 v196, v200, v201
  v_cvt_pk_bf16_f32 v197, v202, v203
  s_waitcnt lgkmcnt(0)
  v_mfma_f32_32x32x16_bf16 v[112:127], v[84:87], v[252:255], v[112:127]
  v_cvt_pk_bf16_f32 v208, v208, v209
  v_cvt_pk_bf16_f32 v209, v210, v211
  v_cvt_pk_bf16_f32 v210, v212, v213
  v_cvt_pk_bf16_f32 v211, v214, v215
  v_cvt_pk_bf16_f32 v198, v204, v205
  v_cvt_pk_bf16_f32 v199, v206, v207
  v_mfma_f32_32x32x16_bf16 v[144:159], v[108:111], v[252:255], v[144:159]
  v_cvt_pk_bf16_f32 v212, v216, v217
  v_cvt_pk_bf16_f32 v213, v218, v219
  v_cvt_pk_bf16_f32 v214, v220, v221
  v_cvt_pk_bf16_f32 v215, v222, v223
  ds_write_b128 v3, v[192:195] offset:0
  v_cvt_pk_bf16_f32 v112, v112, v113
  v_cvt_pk_bf16_f32 v113, v114, v115
  v_cvt_pk_bf16_f32 v114, v116, v117
  v_cvt_pk_bf16_f32 v115, v118, v119
  v_cvt_pk_bf16_f32 v116, v120, v121
  v_cvt_pk_bf16_f32 v117, v122, v123
  v_cvt_pk_bf16_f32 v118, v124, v125
  v_cvt_pk_bf16_f32 v119, v126, v127
  ds_write_b128 v3, v[196:199] offset:1024
  ds_write_b128 v3, v[208:211] offset:128
  ds_write_b128 v3, v[212:215] offset:1152
  v_cvt_pk_bf16_f32 v120, v144, v145
  v_cvt_pk_bf16_f32 v121, v146, v147
  v_cvt_pk_bf16_f32 v122, v148, v149
  v_cvt_pk_bf16_f32 v123, v150, v151
  v_cvt_pk_bf16_f32 v124, v152, v153
  v_cvt_pk_bf16_f32 v125, v154, v155
  v_cvt_pk_bf16_f32 v126, v156, v157
  v_cvt_pk_bf16_f32 v127, v158, v159
  v_lshlrev_b32 v164, 16, v26
  v_and_b32 v165, s31, v26
  v_lshlrev_b32 v166, 16, v27
  v_and_b32 v167, s31, v27
  v_lshlrev_b32 v168, 16, v28
  v_and_b32 v169, s31, v28
  v_lshlrev_b32 v170, 16, v29
  v_and_b32 v171, s31, v29
  v_lshlrev_b32 v172, 16, v30
  v_and_b32 v173, s31, v30
  v_lshlrev_b32 v174, 16, v31
  v_and_b32 v175, s31, v31
  v_lshlrev_b32 v144, 16, v48
  v_and_b32 v145, s31, v48
  v_mfma_f32_32x32x16_bf16 v[160:175], v[224:227], v[176:179], v[160:175]
  v_lshlrev_b32 v146, 16, v49
  v_and_b32 v147, s31, v49
  v_lshlrev_b32 v148, 16, v50
  v_and_b32 v149, s31, v50
  v_lshlrev_b32 v150, 16, v51
  v_and_b32 v151, s31, v51
  v_mfma_f32_32x32x16_bf16 v[160:175], v[228:231], v[180:183], v[160:175]
  v_lshlrev_b32 v152, 16, v52
  v_and_b32 v153, s31, v52
  v_lshlrev_b32 v154, 16, v53
  v_and_b32 v155, s31, v53
  v_lshlrev_b32 v156, 16, v54
  v_and_b32 v157, s31, v54
  v_lshlrev_b32 v158, 16, v55
  v_and_b32 v159, s31, v55
  v_lshlrev_b32 v192, 16, v32
  v_and_b32 v193, s31, v32
  v_mfma_f32_32x32x16_bf16 v[144:159], v[232:235], v[184:187], v[144:159]
  v_lshlrev_b32 v194, 16, v33
  v_and_b32 v195, s31, v33
  v_lshlrev_b32 v196, 16, v34
  v_and_b32 v197, s31, v34
  v_lshlrev_b32 v198, 16, v35
  v_and_b32 v199, s31, v35
  v_mfma_f32_32x32x16_bf16 v[144:159], v[236:239], v[188:191], v[144:159]
  v_lshlrev_b32 v200, 16, v36
  v_and_b32 v201, s31, v36
  v_lshlrev_b32 v202, 16, v37
  v_and_b32 v203, s31, v37
  v_lshlrev_b32 v204, 16, v38
  v_and_b32 v205, s31, v38
  v_lshlrev_b32 v206, 16, v39
  v_and_b32 v207, s31, v39
  v_lshlrev_b32 v208, 16, v56
  v_and_b32 v209, s31, v56
  v_mfma_f32_32x32x16_bf16 v[192:207], v[112:115], v[176:179], v[192:207]
  v_lshlrev_b32 v210, 16, v57
  v_and_b32 v211, s31, v57
  v_lshlrev_b32 v212, 16, v58
  v_and_b32 v213, s31, v58
  v_lshlrev_b32 v214, 16, v59
  v_and_b32 v215, s31, v59
  v_mfma_f32_32x32x16_bf16 v[192:207], v[116:119], v[180:183], v[192:207]
  v_lshlrev_b32 v216, 16, v60
  v_and_b32 v217, s31, v60
  v_lshlrev_b32 v218, 16, v61
  v_and_b32 v219, s31, v61
  v_lshlrev_b32 v220, 16, v62
  v_and_b32 v221, s31, v62
  v_lshlrev_b32 v222, 16, v63
  v_and_b32 v223, s31, v63
  v_cvt_pk_bf16_f32 v160, v160, v161
  v_cvt_pk_bf16_f32 v144, v144, v145
  v_mfma_f32_32x32x16_bf16 v[208:223], v[120:123], v[184:187], v[208:223]
  v_cvt_pk_bf16_f32 v161, v162, v163
  v_cvt_pk_bf16_f32 v145, v146, v147
  v_cvt_pk_bf16_f32 v192, v192, v193
  v_cvt_pk_bf16_f32 v193, v194, v195
  v_cvt_pk_bf16_f32 v162, v164, v165
  v_cvt_pk_bf16_f32 v163, v166, v167
  v_mfma_f32_32x32x16_bf16 v[208:223], v[124:127], v[188:191], v[208:223]
  v_cvt_pk_bf16_f32 v146, v148, v149
  v_cvt_pk_bf16_f32 v147, v150, v151
  v_cvt_pk_bf16_f32 v194, v196, v197
  v_cvt_pk_bf16_f32 v195, v198, v199
  v_cvt_pk_bf16_f32 v164, v168, v169
  v_cvt_pk_bf16_f32 v165, v170, v171
  v_cvt_pk_bf16_f32 v166, v172, v173
  v_cvt_pk_bf16_f32 v167, v174, v175
  v_cvt_pk_bf16_f32 v148, v152, v153
  v_cvt_pk_bf16_f32 v149, v154, v155
  v_cvt_pk_bf16_f32 v150, v156, v157
  v_cvt_pk_bf16_f32 v151, v158, v159
  v_cvt_pk_bf16_f32 v196, v200, v201
  v_cvt_pk_bf16_f32 v197, v202, v203
  v_cvt_pk_bf16_f32 v208, v208, v209
  v_cvt_pk_bf16_f32 v209, v210, v211
  v_cvt_pk_bf16_f32 v210, v212, v213
  v_cvt_pk_bf16_f32 v211, v214, v215
  v_cvt_pk_bf16_f32 v198, v204, v205
  v_cvt_pk_bf16_f32 v199, v206, v207
  v_cvt_pk_bf16_f32 v212, v216, v217
  v_cvt_pk_bf16_f32 v213, v218, v219
  v_cvt_pk_bf16_f32 v214, v220, v221
  v_cvt_pk_bf16_f32 v215, v222, v223
  ds_write_b128 v3, v[160:163] offset:2048
  ds_write_b128 v3, v[164:167] offset:3072
  ds_write_b128 v3, v[144:147] offset:2176
  ds_write_b128 v3, v[148:151] offset:3200
  ds_write_b128 v3, v[192:195] offset:4096
  ds_write_b128 v3, v[196:199] offset:5120
  ds_write_b128 v3, v[208:211] offset:4224
  ds_write_b128 v3, v[212:215] offset:5248
  buffer_load_dwordx4 v[64:67], v7, s[20:23], s52 offen offset:0
  buffer_load_dwordx4 v[68:71], v7, s[20:23], s53 offen offset:0
  buffer_load_dwordx4 v[72:75], v7, s[20:23], s54 offen offset:0
  buffer_load_dwordx4 v[76:79], v7, s[20:23], s55 offen offset:0
  buffer_load_dwordx4 v[80:83], v7, s[20:23], s56 offen offset:0
  buffer_load_dwordx4 v[84:87], v7, s[20:23], s57 offen offset:0
  buffer_load_dwordx4 v[88:91], v7, s[20:23], s58 offen offset:0
  buffer_load_dwordx4 v[92:95], v7, s[20:23], s59 offen offset:0
  buffer_load_dwordx4 v[240:243], v6, s[20:23], s60 offen offset:0
  buffer_load_dwordx4 v[244:247], v6, s[20:23], s60 offen offset:1024
  buffer_load_dwordx4 v[248:251], v6, s[20:23], s60 offen offset:2048
  buffer_load_dwordx4 v[252:255], v6, s[20:23], s60 offen offset:3072
  s_waitcnt lgkmcnt(0)
  s_barrier
  s_cmp_eq_u32 s61, 0
  s_cbranch_scc1 L_Ttail
L_R2:
  ds_read_b128 v[16:19], v4 offset:0
  ds_read_b128 v[40:43], v4 offset:6144
  ds_read_b128 v[20:23], v4 offset:1024
  ds_read_b128 v[44:47], v4 offset:7168
  ds_read_b128 v[24:27], v4 offset:2048
  ds_read_b128 v[48:51], v4 offset:8192
  ds_read_b128 v[28:31], v4 offset:3072
  ds_read_b128 v[52:55], v4 offset:9216
  ds_read_b128 v[32:35], v4 offset:4096
  ds_read_b128 v[56:59], v4 offset:10240
  ds_read_b128 v[36:39], v4 offset:5120
  ds_read_b128 v[60:63], v4 offset:11264
  v_mov_b32 v208, 0
  v_mov_b32 v209, 0
  v_mov_b32 v210, 0
  v_mov_b32 v211, 0
  v_mov_b32 v216, 0
  v_mov_b32 v217, 0
  v_mov_b32 v218, 0
  v_mov_b32 v219, 0
  s_waitcnt vmcnt(11)
  ds_write_b128 v7, v[64:67] offset:0
  s_waitcnt vmcnt(10)
  ds_write_b128 v7, v[68:71] offset:4096
  s_waitcnt vmcnt(9)
  ds_write_b128 v7, v[72:75] offset:8192
  s_waitcnt vmcnt(8)
  ds_write_b128 v7, v[76:79] offset:12288
  s_waitcnt vmcnt(7)
  ds_write_b128 v7, v[80:83] offset:16384
  s_waitcnt vmcnt(6)
  ds_write_b128 v7, v[84:87] offset:20480
  s_waitcnt vmcnt(5)
  ds_write_b128 v7, v[88:91] offset:24576
  s_waitcnt vmcnt(4)
  ds_write_b128 v7, v[92:95] offset:28672
  s_waitcnt lgkmcnt(15)
  v_dot2c_f32_bf16 v208, s30, v16
  v_dot2c_f32_bf16 v210, v16, v16
  v_dot2c_f32_bf16 v209, s30, v17
  v_dot2c_f32_bf16 v211, v17, v17
  v_dot2c_f32_bf16 v216, s30, v40
  v_dot2c_f32_bf16 v218, v40, v40
  v_dot2c_f32_bf16 v217, s30, v41
  v_dot2c_f32_bf16 v219, v41, v41
  v_dot2c_f32_bf16 v208, s30, v18
  v_dot2c_f32_bf16 v210, v18, v18
  v_dot2c_f32_bf16 v209, s30, v19
  v_dot2c_f32_bf16 v211, v19, v19
  v_dot2c_f32_bf16 v216, s30, v42
  v_dot2c_f32_bf16 v218, v42, v42
  v_dot2c_f32_bf16 v217, s30, v43
  v_dot2c_f32_bf16 v219, v43, v43
  v_dot2c_f32_bf16 v208, s30, v20
  v_dot2c_f32_bf16 v210, v20, v20
  v_dot2c_f32_bf16 v209, s30, v21
  v_dot2c_f32_bf16 v211, v21, v21
  v_dot2c_f32_bf16 v216, s30, v44
  v_dot2c_f32_bf16 v218, v44, v44
  v_dot2c_f32_bf16 v217, s30, v45
  v_dot2c_f32_bf16 v219, v45, v45
  v_dot2c_f32_bf16 v208, s30, v22
  v_dot2c_f32_bf16 v210, v22, v22
  v_dot2c_f32_bf16 v209, s30, v23
  v_dot2c_f32_bf16 v211, v23, v23
  v_dot2c_f32_bf16 v216, s30, v46
  v_dot2c_f32_bf16 v218, v46, v46
  v_dot2c_f32_bf16 v217, s30, v47
  v_dot2c_f32_bf16 v219, v47, v47
  v_dot2c_f32_bf16 v208, s30, v24
  v_dot2c_f32_bf16 v210, v24, v24
  v_dot2c_f32_bf16 v209, s30, v25
  v_dot2c_f32_bf16 v211, v25, v25
  s_waitcnt lgkmcnt(14)
  v_dot2c_f32_bf16 v216, s30, v48
  v_dot2c_f32_bf16 v218, v48, v48
  v_dot2c_f32_bf16 v217, s30, v49
  v_dot2c_f32_bf16 v219, v49, v49
  v_dot2c_f32_bf16 v208, s30, v26
  v_dot2c_f32_bf16 v210, v26, v26
  v_dot2c_f32_bf16 v209, s30, v27
  v_dot2c_f32_bf16 v211, v27, v27
  v_dot2c_f32_bf16 v216, s30, v50
  v_dot2c_f32_bf16 v218, v50, v50
  v_dot2c_f32_bf16 v217, s30, v51
  v_dot2c_f32_bf16 v219, v51, v51
  s_waitcnt lgkmcnt(13)
  v_dot2c_f32_bf16 v208, s30, v28
  v_dot2c_f32_bf16 v210, v28, v28
  v_dot2c_f32_bf16 v209, s30, v29
  v_dot2c_f32_bf16 v211, v29, v29
  s_waitcnt lgkmcnt(12)
  v_dot2c_f32_bf16 v216, s30, v52
  v_dot2c_f32_bf16 v218, v52, v52
  v_dot2c_f32_bf16 v217, s30, v53
  v_dot2c_f32_bf16 v219, v53, v53
  v_dot2c_f32_bf16 v208, s30, v30
  v_dot2c_f32_bf16 v210, v30, v30
  v_dot2c_f32_bf16 v209, s30, v31
  v_dot2c_f32_bf16 v211, v31, v31
  v_dot2c_f32_bf16 v216, s30, v54
  v_dot2c_f32_bf16 v218, v54, v54
  v_dot2c_f32_bf16 v217, s30, v55
  v_dot2c_f32_bf16 v219, v55, v55
  s_waitcnt lgkmcnt(11)
  v_dot2c_f32_bf16 v208, s30, v32
  v_dot2c_f32_bf16 v210, v32, v32
  v_dot2c_f32_bf16 v209, s30, v33
  v_dot2c_f32_bf16 v211, v33, v33
  s_waitcnt lgkmcnt(10)
  v_dot2c_f32_bf16 v216, s30, v56
  v_dot2c_f32_bf16 v218, v56, v56
  v_dot2c_f32_bf16 v217, s30, v57
  v_dot2c_f32_bf16 v219, v57, v57
  v_dot2c_f32_bf16 v208, s30, v34
  v_dot2c_f32_bf16 v210, v34, v34
  v_dot2c_f32_bf16 v209, s30, v35
  v_dot2c_f32_bf16 v211, v35, v35
  v_dot2c_f32_bf16 v216, s30, v58
  v_dot2c_f32_bf16 v218, v58, v58
  v_dot2c_f32_bf16 v217, s30, v59
  v_dot2c_f32_bf16 v219, v59, v59
  s_waitcnt lgkmcnt(9)
  v_dot2c_f32_bf16 v208, s30, v36
  v_dot2c_f32_bf16 v210, v36, v36
  v_dot2c_f32_bf16 v209, s30, v37
  v_dot2c_f32_bf16 v211, v37, v37
  s_waitcnt lgkmcnt(8)
  v_dot2c_f32_bf16 v216, s30, v60
  v_dot2c_f32_bf16 v218, v60, v60
  v_dot2c_f32_bf16 v217, s30, v61
  v_dot2c_f32_bf16 v219, v61, v61
  v_dot2c_f32_bf16 v208, s30, v38
  v_dot2c_f32_bf16 v210, v38, v38
  v_dot2c_f32_bf16 v209, s30, v39
  v_dot2c_f32_bf16 v211, v39, v39
  v_dot2c_f32_bf16 v216, s30, v62
  v_dot2c_f32_bf16 v218, v62, v62
  v_dot2c_f32_bf16 v217, s30, v63
  v_dot2c_f32_bf16 v219, v63, v63
  v_add_f32 v208, v208, v209
  v_add_f32 v210, v210, v211
  v_add_f32 v216, v216, v217
  v_add_f32 v218, v218, v219
  v_permlane32_swap_b32 v208, v210
  v_add_f32 v208, v208, v210
  v_permlane32_swap_b32 v216, v218
  v_mov_b32 v210, v208
  v_add_f32 v216, v216, v218
  v_mov_b32 v218, v216
  v_permlane32_swap_b32 v208, v210
  v_mul_f32 v208, 0x3c2aaaab, v208
  v_permlane32_swap_b32 v216, v218
  v_mul_f32 v210, 0x3c2aaaab, v210
  v_mul_f32 v216, 0x3c2aaaab, v216
  v_mul_f32 v218, 0x3c2aaaab, v218
  v_fma_f32 v210, -v208, v208, v210
  v_fma_f32 v218, -v216, v216, v218
  v_max_f32 v210, 0, v210
  v_max_f32 v218, 0, v218
  v_add_f32 v210, 0x3727c5ac, v210
  v_add_f32 v218, 0x3727c5ac, v218
  v_rsq_f32 v212, v210
  v_rsq_f32 v220, v218
  v_mul_f32 v213, -v208, v212
  v_mul_f32 v221, -v216, v220
  s_waitcnt lgkmcnt(0)
  s_barrier
  s_waitcnt vmcnt(0)
  s_add_u32 s87, s2, 512
  s_cmp_ge_u32 s87, 784
  s_cbranch_scc1 L_nopf
  s_sub_u32 s87, s87, 32
  s_mul_i32 s88, s87, 2341
  s_lshr_b32 s88, s88, 16
  s_mul_i32 s89, s88, 28
  s_sub_u32 s89, s87, s89
  s_mul_i32 s88, s88, 344064
  s_mul_i32 s89, s89, 1536
  s_add_u32 s88, s88, s89
  s_mul_i32 s89, s24, 86016
  s_add_u32 s88, s88, s89
  s_mov_b32 s84, -1
  s_mov_b32 s85, 0
  v_add_u32 v8, 0x400, v6
  v_add_u32 v10, 42496, v6
  v_cndmask_b32 v8, v10, v8, s[84:85]
  v_add_u32 v9, 43520, v6
  s_mul_i32 s86, s24, 12288
  s_add_u32 s86, s86, 32768
  s_add_u32 m0, s86, 0
  s_nop 0
  buffer_load_dwordx4 v6, s[12:15], s88 offen lds
  s_add_u32 m0, s86, 1024
  s_nop 0
  buffer_load_dwordx4 v8, s[12:15], s88 offen lds
  s_add_u32 m0, s86, 2048
  s_nop 0
  buffer_load_dwordx4 v9, s[12:15], s88 offen lds
  s_add_u32 s88, s88, 9633792
  s_add_u32 m0, s86, 3072
  s_nop 0
  buffer_load_dwordx4 v6, s[12:15], s88 offen lds
  s_add_u32 m0, s86, 4096
  s_nop 0
  buffer_load_dwordx4 v8, s[12:15], s88 offen lds
  s_add_u32 m0, s86, 5120
  s_nop 0
  buffer_load_dwordx4 v9, s[12:15], s88 offen lds
  s_add_u32 s88, s88, 9633792
  s_add_u32 m0, s86, 6144
  s_nop 0
  buffer_load_dwordx4 v6, s[12:15], s88 offen lds
  s_add_u32 m0, s86, 7168
  s_nop 0
  buffer_load_dwordx4 v8, s[12:15], s88 offen lds
  s_add_u32 m0, s86, 8192
  s_nop 0
  buffer_load_dwordx4 v9, s[12:15], s88 offen lds
  s_add_u32 s88, s88, 9633792
  s_add_u32 m0, s86, 9216
  s_nop 0
  buffer_load_dwordx4 v6, s[12:15], s88 offen lds
  s_add_u32 m0, s86, 10240
  s_nop 0
  buffer_load_dwordx4 v8, s[12:15], s88 offen lds
  s_add_u32 m0, s86, 11264
  s_nop 0
  buffer_load_dwordx4 v9, s[12:15], s88 offen lds
L_nopf:
  s_nop 1
  v_lshlrev_b32 v224, 16, v16
  v_and_b32 v225, s31, v16
  v_lshlrev_b32 v226, 16, v17
  v_and_b32 v227, s31, v17
  v_lshlrev_b32 v228, 16, v18
  v_and_b32 v229, s31, v18
  v_lshlrev_b32 v230, 16, v19
  v_and_b32 v231, s31, v19
  v_lshlrev_b32 v232, 16, v40
  v_and_b32 v233, s31, v40
  v_lshlrev_b32 v234, 16, v41
  v_and_b32 v235, s31, v41
  v_lshlrev_b32 v236, 16, v42
  v_and_b32 v237, s31, v42
  v_lshlrev_b32 v238, 16, v43
  v_and_b32 v239, s31, v43
  v_fma_f32 v224, v224, v212, v213
  v_fma_f32 v225, v225, v212, v213
  v_fma_f32 v226, v226, v212, v213
  v_fma_f32 v227, v227, v212, v213
  v_fma_f32 v228, v228, v212, v213
  v_fma_f32 v229, v229, v212, v213
  v_fma_f32 v230, v230, v212, v213
  v_fma_f32 v231, v231, v212, v213
  v_fma_f32 v232, v232, v220, v221
  v_fma_f32 v233, v233, v220, v221
  v_fma_f32 v234, v234, v220, v221
  v_fma_f32 v235, v235, v220, v221
  v_fma_f32 v236, v236, v220, v221
  v_fma_f32 v237, v237, v220, v221
  v_fma_f32 v238, v238, v220, v221
  v_fma_f32 v239, v239, v220, v221
  v_cvt_pk_bf16_f32 v64, v224, v225
  v_cvt_pk_bf16_f32 v65, v226, v227
  v_cvt_pk_bf16_f32 v66, v228, v229
  v_cvt_pk_bf16_f32 v67, v230, v231
  v_cvt_pk_bf16_f32 v88, v232, v233
  v_cvt_pk_bf16_f32 v89, v234, v235
  v_mfma_f32_32x32x16_bf16 v[144:159], v[244:247], v[64:67], 0
  v_cvt_pk_bf16_f32 v90, v236, v237
  v_cvt_pk_bf16_f32 v91, v238, v239
  v_lshlrev_b32 v224, 16, v20
  v_and_b32 v225, s31, v20
  v_lshlrev_b32 v226, 16, v21
  v_and_b32 v227, s31, v21
  v_mfma_f32_32x32x16_bf16 v[160:175], v[244:247], v[88:91], 0
  ds_read_b128 v[244:247], v6 offset:1024
  v_lshlrev_b32 v228, 16, v22
  v_and_b32 v229, s31, v22
  v_lshlrev_b32 v230, 16, v23
  v_and_b32 v231, s31, v23
  v_lshlrev_b32 v232, 16, v44
  v_mfma_f32_32x32x16_bf16 v[112:127], v[240:243], v[64:67], 0
  v_and_b32 v233, s31, v44
  v_lshlrev_b32 v234, 16, v45
  v_and_b32 v235, s31, v45
  v_lshlrev_b32 v236, 16, v46
  v_and_b32 v237, s31, v46
  v_lshlrev_b32 v238, 16, v47
  v_mfma_f32_32x32x16_bf16 v[128:143], v[240:243], v[88:91], 0
  ds_read_b128 v[240:243], v6 offset:0
  v_and_b32 v239, s31, v47
  v_fma_f32 v224, v224, v212, v213
  v_fma_f32 v225, v225, v212, v213
  v_fma_f32 v226, v226, v212, v213
  v_fma_f32 v227, v227, v212, v213
  v_mfma_f32_32x32x16_bf16 v[176:191], v[248:251], v[64:67], 0
  v_fma_f32 v228, v228, v212, v213
  v_fma_f32 v229, v229, v212, v213
  v_fma_f32 v230, v230, v212, v213
  v_fma_f32 v231, v231, v212, v213
  v_fma_f32 v232, v232, v220, v221
  v_fma_f32 v233, v233, v220, v221
  v_mfma_f32_32x32x16_bf16 v[192:207], v[248:251], v[88:91], 0
  v_fma_f32 v234, v234, v220, v221
  v_fma_f32 v235, v235, v220, v221
  v_fma_f32 v236, v236, v220, v221
  v_fma_f32 v237, v237, v220, v221
  v_fma_f32 v238, v238, v220, v221
  v_fma_f32 v239, v239, v220, v221
  ds_read_b128 v[248:251], v6 offset:2048
  v_cvt_pk_bf16_f32 v68, v224, v225
  v_cvt_pk_bf16_f32 v69, v226, v227
  v_cvt_pk_bf16_f32 v70, v228, v229
  v_cvt_pk_bf16_f32 v71, v230, v231
  v_cvt_pk_bf16_f32 v92, v232, v233
  v_cvt_pk_bf16_f32 v93, v234, v235
  v_mfma_f32_32x32x16_bf16 v[112:127], v[252:255], v[68:71], v[112:127]
  v_cvt_pk_bf16_f32 v94, v236, v237
  v_cvt_pk_bf16_f32 v95, v238, v239
  v_lshlrev_b32 v224, 16, v24
  v_and_b32 v225, s31, v24
  v_lshlrev_b32 v226, 16, v25
  v_and_b32 v227, s31, v25
  v_mfma_f32_32x32x16_bf16 v[128:143], v[252:255], v[92:95], v[128:143]
  ds_read_b128 v[252:255], v6 offset:3072
  v_lshlrev_b32 v228, 16, v26
  v_and_b32 v229, s31, v26
  v_lshlrev_b32 v230, 16, v27
  v_and_b32 v231, s31, v27
  v_lshlrev_b32 v232, 16, v48
  s_waitcnt lgkmcnt(3)
  v_mfma_f32_32x32x16_bf16 v[176:191], v[244:247], v[68:71], v[176:191]
  v_and_b32 v233, s31, v48
  v_lshlrev_b32 v234, 16, v49
  v_and_b32 v235, s31, v49
  v_lshlrev_b32 v236, 16, v50
  v_and_b32 v237, s31, v50
  v_lshlrev_b32 v238, 16, v51
  v_mfma_f32_32x32x16_bf16 v[192:207], v[244:247], v[92:95], v[192:207]
  ds_read_b128 v[244:247], v6 offset:5120
  v_and_b32 v239, s31, v51
  v_fma_f32 v224, v224, v212, v213
  v_fma_f32 v225, v225, v212, v213
  v_fma_f32 v226, v226, v212, v213
  v_fma_f32 v227, v227, v212, v213
  s_waitcnt lgkmcnt(3)
  v_mfma_f32_32x32x16_bf16 v[144:159], v[240:243], v[68:71], v[144:159]
  v_fma_f32 v228, v228, v212, v213
  v_fma_f32 v229, v229, v212, v213
  v_fma_f32 v230, v230, v212, v213
  v_fma_f32 v231, v231, v212, v213
  v_fma_f32 v232, v232, v220, v221
  v_fma_f32 v233, v233, v220, v221
  v_mfma_f32_32x32x16_bf16 v[160:175], v[240:243], v[92:95], v[160:175]
  ds_read_b128 v[240:243], v6 offset:4096
  v_fma_f32 v234, v234, v220, v221
  v_fma_f32 v235, v235, v220, v221
  v_fma_f32 v236, v236, v220, v221
  v_fma_f32 v237, v237, v220, v221
  v_fma_f32 v238, v238, v220, v221
  v_fma_f32 v239, v239, v220, v221
  v_cvt_pk_bf16_f32 v72, v224, v225
  v_cvt_pk_bf16_f32 v73, v226, v227
  v_cvt_pk_bf16_f32 v74, v228, v229
  v_cvt_pk_bf16_f32 v75, v230, v231
  v_cvt_pk_bf16_f32 v96, v232, v233
  v_cvt_pk_bf16_f32 v97, v234, v235
  s_waitcnt lgkmcnt(3)
  v_mfma_f32_32x32x16_bf16 v[112:127], v[248:251], v[72:75], v[112:127]
  v_cvt_pk_bf16_f32 v98, v236, v237
  v_cvt_pk_bf16_f32 v99, v238, v239
  v_lshlrev_b32 v224, 16, v28
  v_and_b32 v225, s31, v28
  v_lshlrev_b32 v226, 16, v29
  v_and_b32 v227, s31, v29
  v_mfma_f32_32x32x16_bf16 v[128:143], v[248:251], v[96:99], v[128:143]
  v_lshlrev_b32 v228, 16, v30
  v_and_b32 v229, s31, v30
  v_lshlrev_b32 v230, 16, v31
  v_and_b32 v231, s31, v31
  v_lshlrev_b32 v232, 16, v52
  v_and_b32 v233, s31, v52
  s_waitcnt lgkmcnt(2)
  v_mfma_f32_32x32x16_bf16 v[144:159], v[252:255], v[72:75], v[144:159]
  v_lshlrev_b32 v234, 16, v53
  v_and_b32 v235, s31, v53
  v_lshlrev_b32 v236, 16, v54
  v_and_b32 v237, s31, v54
  v_lshlrev_b32 v238, 16, v55
  v_and_b32 v239, s31, v55
  v_mfma_f32_32x32x16_bf16 v[160:175], v[252:255], v[96:99], v[160:175]
  ds_read_b128 v[248:251], v6 offset:6144
  v_fma_f32 v224, v224, v212, v213
  v_fma_f32 v225, v225, v212, v213
  v_fma_f32 v226, v226, v212, v213
  v_fma_f32 v227, v227, v212, v213
  v_fma_f32 v228, v228, v212, v213
  s_waitcnt lgkmcnt(1)
  v_mfma_f32_32x32x16_bf16 v[176:191], v[240:243], v[72:75], v[176:191]
  v_fma_f32 v229, v229, v212, v213
  v_fma_f32 v230, v230, v212, v213
  v_fma_f32 v231, v231, v212, v213
  v_fma_f32 v232, v232, v220, v221
  v_fma_f32 v233, v233, v220, v221
  v_fma_f32 v234, v234, v220, v221
  v_mfma_f32_32x32x16_bf16 v[192:207], v[240:243], v[96:99], v[192:207]
  v_fma_f32 v235, v235, v220, v221
  v_fma_f32 v236, v236, v220, v221
  v_fma_f32 v237, v237, v220, v221
  v_fma_f32 v238, v238, v220, v221
  v_fma_f32 v239, v239, v220, v221
  v_cvt_pk_bf16_f32 v76, v224, v225
  v_cvt_pk_bf16_f32 v77, v226, v227
  v_cvt_pk_bf16_f32 v78, v228, v229
  v_cvt_pk_bf16_f32 v79, v230, v231
  v_cvt_pk_bf16_f32 v100, v232, v233
  v_cvt_pk_bf16_f32 v101, v234, v235
  v_mfma_f32_32x32x16_bf16 v[112:127], v[244:247], v[76:79], v[112:127]
  v_cvt_pk_bf16_f32 v102, v236, v237
  v_cvt_pk_bf16_f32 v103, v238, v239
  ds_read_b128 v[252:255], v6 offset:7168
  ds_read_b128 v[240:243], v6 offset:8192
  v_lshlrev_b32 v224, 16, v32
  v_and_b32 v225, s31, v32
  v_mfma_f32_32x32x16_bf16 v[128:143], v[244:247], v[100:103], v[128:143]
  ds_read_b128 v[244:247], v6 offset:9216
  v_lshlrev_b32 v226, 16, v33
  v_and_b32 v227, s31, v33
  v_lshlrev_b32 v228, 16, v34
  v_and_b32 v229, s31, v34
  v_lshlrev_b32 v230, 16, v35
  s_waitcnt lgkmcnt(3)
  v_mfma_f32_32x32x16_bf16 v[144:159], v[248:251], v[76:79], v[144:159]
  v_and_b32 v231, s31, v35
  v_lshlrev_b32 v232, 16, v56
  v_and_b32 v233, s31, v56
  v_lshlrev_b32 v234, 16, v57
  v_and_b32 v235, s31, v57
  v_lshlrev_b32 v236, 16, v58
  v_mfma_f32_32x32x16_bf16 v[160:175], v[248:251], v[100:103], v[160:175]
  v_and_b32 v237, s31, v58
  v_lshlrev_b32 v238, 16, v59
  v_and_b32 v239, s31, v59
  ds_read_b128 v[248:251], v6 offset:10240
  v_fma_f32 v224, v224, v212, v213
  v_fma_f32 v225, v225, v212, v213
  v_fma_f32 v226, v226, v212, v213
  v_fma_f32 v227, v227, v212, v213
  v_fma_f32 v228, v228, v212, v213
  v_fma_f32 v229, v229, v212, v213
  v_fma_f32 v230, v230, v212, v213
  v_fma_f32 v231, v231, v212, v213
  v_fma_f32 v232, v232, v220, v221
  s_waitcnt lgkmcnt(3)
  v_mfma_f32_32x32x16_bf16 v[176:191], v[252:255], v[76:79], v[176:191]
  v_fma_f32 v233, v233, v220, v221
  v_fma_f32 v234, v234, v220, v221
  v_fma_f32 v235, v235, v220, v221
  v_fma_f32 v236, v236, v220, v221
  v_fma_f32 v237, v237, v220, v221
  v_fma_f32 v238, v238, v220, v221
  v_mfma_f32_32x32x16_bf16 v[192:207], v[252:255], v[100:103], v[192:207]
  v_fma_f32 v239, v239, v220, v221
  v_cvt_pk_bf16_f32 v80, v224, v225
  v_cvt_pk_bf16_f32 v81, v226, v227
  v_cvt_pk_bf16_f32 v82, v228, v229
  v_cvt_pk_bf16_f32 v83, v230, v231
  v_cvt_pk_bf16_f32 v104, v232, v233
  v_cvt_pk_bf16_f32 v105, v234, v235
  s_waitcnt lgkmcnt(1)
  v_mfma_f32_32x32x16_bf16 v[144:159], v[244:247], v[80:83], v[144:159]
  v_cvt_pk_bf16_f32 v106, v236, v237
  v_cvt_pk_bf16_f32 v107, v238, v239
  ds_read_b128 v[252:255], v6 offset:11264
  v_lshlrev_b32 v224, 16, v36
  v_and_b32 v225, s31, v36
  v_lshlrev_b32 v226, 16, v37
  v_mfma_f32_32x32x16_bf16 v[160:175], v[244:247], v[104:107], v[160:175]
  ds_read_b128 v[244:247], v6 offset:13312
  v_and_b32 v227, s31, v37
  v_lshlrev_b32 v228, 16, v38
  v_and_b32 v229, s31, v38
  v_lshlrev_b32 v230, 16, v39
  v_and_b32 v231, s31, v39
  v_mfma_f32_32x32x16_bf16 v[112:127], v[240:243], v[80:83], v[112:127]
  v_lshlrev_b32 v232, 16, v60
  v_and_b32 v233, s31, v60
  v_lshlrev_b32 v234, 16, v61
  v_and_b32 v235, s31, v61
  v_lshlrev_b32 v236, 16, v62
  v_and_b32 v237, s31, v62
  v_mfma_f32_32x32x16_bf16 v[128:143], v[240:243], v[104:107], v[128:143]
  ds_read_b128 v[240:243], v6 offset:12288
  v_lshlrev_b32 v238, 16, v63
  v_and_b32 v239, s31, v63
  v_fma_f32 v224, v224, v212, v213
  v_fma_f32 v225, v225, v212, v213
  v_fma_f32 v226, v226, v212, v213
  s_waitcnt lgkmcnt(3)
  v_mfma_f32_32x32x16_bf16 v[176:191], v[248:251], v[80:83], v[176:191]
  v_fma_f32 v227, v227, v212, v213
  v_fma_f32 v228, v228, v212, v213
  v_fma_f32 v229, v229, v212, v213
  v_fma_f32 v230, v230, v212, v213
  v_fma_f32 v231, v231, v212, v213
  v_fma_f32 v232, v232, v220, v221
  v_mfma_f32_32x32x16_bf16 v[192:207], v[248:251], v[104:107], v[192:207]
  v_fma_f32 v233, v233, v220, v221
  v_fma_f32 v234, v234, v220, v221
  v_fma_f32 v235, v235, v220, v221
  v_fma_f32 v236, v236, v220, v221
  v_fma_f32 v237, v237, v220, v221
  v_fma_f32 v238, v238, v220, v221
  v_fma_f32 v239, v239, v220, v221
  ds_read_b128 v[248:251], v6 offset:14336
  v_cvt_pk_bf16_f32 v84, v224, v225
  v_cvt_pk_bf16_f32 v85, v226, v227
  v_cvt_pk_bf16_f32 v86, v228, v229
  v_cvt_pk_bf16_f32 v87, v230, v231
  v_cvt_pk_bf16_f32 v108, v232, v233
  v_cvt_pk_bf16_f32 v109, v234, v235
  s_waitcnt lgkmcnt(3)
  v_mfma_f32_32x32x16_bf16 v[112:127], v[252:255], v[84:87], v[112:127]
  v_cvt_pk_bf16_f32 v110, v236, v237
  v_cvt_pk_bf16_f32 v111, v238, v239
  s_nop 0
  s_nop 0
  v_mfma_f32_32x32x16_bf16 v[128:143], v[252:255], v[108:111], v[128:143]
  ds_read_b128 v[252:255], v6 offset:15360
  s_waitcnt lgkmcnt(3)
  v_mfma_f32_32x32x16_bf16 v[176:191], v[244:247], v[84:87], v[176:191]
  s_nop 3
  v_cvt_pk_bf16_f32 v112, v112, v113
  v_cvt_pk_bf16_f32 v113, v114, v115
  v_cvt_pk_bf16_f32 v114, v116, v117
  v_cvt_pk_bf16_f32 v115, v118, v119
  v_cvt_pk_bf16_f32 v116, v120, v121
  v_cvt_pk_bf16_f32 v117, v122, v123
  s_waitcnt lgkmcnt(2)
  v_mfma_f32_32x32x16_bf16 v[144:159], v[240:243], v[84:87], v[144:159]
  v_cvt_pk_bf16_f32 v118, v124, v125
  v_cvt_pk_bf16_f32 v119, v126, v127
  v_cvt_pk_bf16_f32 v120, v128, v129
  v_cvt_pk_bf16_f32 v121, v130, v131
  v_cvt_pk_bf16_f32 v122, v132, v133
  v_cvt_pk_bf16_f32 v123, v134, v135
  v_mfma_f32_32x32x16_bf16 v[160:175], v[240:243], v[108:111], v[160:175]
  ds_read_b128 v[240:243], v6 offset:16384
  v_cvt_pk_bf16_f32 v176, v176, v177
  v_cvt_pk_bf16_f32 v177, v178, v179
  v_cvt_pk_bf16_f32 v178, v180, v181
  v_cvt_pk_bf16_f32 v179, v182, v183
  v_cvt_pk_bf16_f32 v180, v184, v185
  v_mfma_f32_32x32x16_bf16 v[192:207], v[244:247], v[108:111], v[192:207]
  ds_read_b128 v[244:247], v6 offset:17408
  v_cvt_pk_bf16_f32 v181, v186, v187
  v_cvt_pk_bf16_f32 v182, v188, v189
  v_cvt_pk_bf16_f32 v183, v190, v191
  v_cvt_pk_bf16_f32 v124, v136, v137
  v_cvt_pk_bf16_f32 v125, v138, v139
  s_waitcnt lgkmcnt(3)
  v_mfma_f32_32x32x16_bf16 v[208:223], v[88:91], v[248:251], 0
  v_cvt_pk_bf16_f32 v126, v140, v141
  v_cvt_pk_bf16_f32 v127, v142, v143
  v_cvt_pk_bf16_f32 v144, v144, v145
  v_cvt_pk_bf16_f32 v145, v146, v147
  v_cvt_pk_bf16_f32 v146, v148, v149
  v_cvt_pk_bf16_f32 v147, v150, v151
  s_waitcnt lgkmcnt(2)
  v_mfma_f32_32x32x16_bf16 v[208:223], v[92:95], v[252:255], v[208:223]
  v_cvt_pk_bf16_f32 v184, v192, v193
  v_cvt_pk_bf16_f32 v185, v194, v195
  v_cvt_pk_bf16_f32 v186, v196, v197
  v_cvt_pk_bf16_f32 v187, v198, v199
  v_cvt_pk_bf16_f32 v188, v200, v201
  v_cvt_pk_bf16_f32 v189, v202, v203
  v_mfma_f32_32x32x16_bf16 v[128:143], v[64:67], v[112:115], 0
  v_cvt_pk_bf16_f32 v190, v204, v205
  v_cvt_pk_bf16_f32 v191, v206, v207
  v_cvt_pk_bf16_f32 v148, v152, v153
  v_cvt_pk_bf16_f32 v149, v154, v155
  v_cvt_pk_bf16_f32 v150, v156, v157
  v_cvt_pk_bf16_f32 v151, v158, v159
  v_mfma_f32_32x32x16_bf16 v[192:207], v[64:67], v[248:251], 0
  ds_read_b128 v[248:251], v6 offset:18432
  v_cvt_pk_bf16_f32 v152, v160, v161
  v_cvt_pk_bf16_f32 v153, v162, v163
  v_cvt_pk_bf16_f32 v154, v164, v165
  v_cvt_pk_bf16_f32 v155, v166, v167
  v_cvt_pk_bf16_f32 v156, v168, v169
  v_mfma_f32_32x32x16_bf16 v[192:207], v[68:71], v[252:255], v[192:207]
  ds_read_b128 v[252:255], v6 offset:19456
  v_cvt_pk_bf16_f32 v157, v170, v171
  v_cvt_pk_bf16_f32 v158, v172, v173
  v_cvt_pk_bf16_f32 v159, v174, v175
  s_waitcnt lgkmcnt(3)
  v_mfma_f32_32x32x16_bf16 v[192:207], v[72:75], v[240:243], v[192:207]
  v_mfma_f32_32x32x16_bf16 v[208:223], v[96:99], v[240:243], v[208:223]
  ds_read_b128 v[240:243], v6 offset:20480
  s_waitcnt lgkmcnt(3)
  v_mfma_f32_32x32x16_bf16 v[192:207], v[76:79], v[244:247], v[192:207]
  v_mfma_f32_32x32x16_bf16 v[208:223], v[100:103], v[244:247], v[208:223]
  ds_read_b128 v[244:247], v6 offset:21504
  s_waitcnt lgkmcnt(3)
  v_mfma_f32_32x32x16_bf16 v[192:207], v[80:83], v[248:251], v[192:207]
  v_mfma_f32_32x32x16_bf16 v[160:175], v[88:91], v[112:115], 0
  v_mfma_f32_32x32x16_bf16 v[128:143], v[68:71], v[116:119], v[128:143]
  v_mfma_f32_32x32x16_bf16 v[208:223], v[104:107], v[248:251], v[208:223]
  ds_read_b128 v[248:251], v6 offset:22528
  s_waitcnt lgkmcnt(3)
  v_mfma_f32_32x32x16_bf16 v[192:207], v[84:87], v[252:255], v[192:207]
  v_mfma_f32_32x32x16_bf16 v[160:175], v[92:95], v[116:119], v[160:175]
  v_mfma_f32_32x32x16_bf16 v[128:143], v[72:75], v[144:147], v[128:143]
  s_nop 9
  v_cvt_pk_bf16_f32 v192, v192, v193
  v_cvt_pk_bf16_f32 v193, v194, v195
  v_cvt_pk_bf16_f32 v194, v196, v197
  v_cvt_pk_bf16_f32 v195, v198, v199
  v_cvt_pk_bf16_f32 v196, v200, v201
  v_cvt_pk_bf16_f32 v197, v202, v203
  v_mfma_f32_32x32x16_bf16 v[208:223], v[108:111], v[252:255], v[208:223]
  v_cvt_pk_bf16_f32 v198, v204, v205
  v_cvt_pk_bf16_f32 v199, v206, v207
  ds_read_b128 v[252:255], v6 offset:23552
  v_mfma_f32_32x32x16_bf16 v[160:175], v[96:99], v[144:147], v[160:175]
  v_mfma_f32_32x32x16_bf16 v[128:143], v[76:79], v[148:151], v[128:143]
  s_nop 6
  v_cvt_pk_bf16_f32 v200, v208, v209
  v_cvt_pk_bf16_f32 v201, v210, v211
  v_cvt_pk_bf16_f32 v202, v212, v213
  v_cvt_pk_bf16_f32 v203, v214, v215
  v_cvt_pk_bf16_f32 v204, v216, v217
  v_cvt_pk_bf16_f32 v205, v218, v219
  v_mfma_f32_32x32x16_bf16 v[160:175], v[100:103], v[148:151], v[160:175]
  v_cvt_pk_bf16_f32 v206, v220, v221
  v_cvt_pk_bf16_f32 v207, v222, v223
  v_mfma_f32_32x32x16_bf16 v[128:143], v[80:83], v[176:179], v[128:143]
  v_mfma_f32_32x32x16_bf16 v[224:239], v[64:67], v[120:123], 0
  v_mfma_f32_32x32x16_bf16 v[208:223], v[88:91], v[120:123], 0
  v_mfma_f32_32x32x16_bf16 v[160:175], v[104:107], v[176:179], v[160:175]
  v_mfma_f32_32x32x16_bf16 v[128:143], v[84:87], v[180:183], v[128:143]
  v_mfma_f32_32x32x16_bf16 v[224:239], v[68:71], v[124:127], v[224:239]
  v_mfma_f32_32x32x16_bf16 v[208:223], v[92:95], v[124:127], v[208:223]
  s_nop 9
  v_max3_f32 v8, v128, v129, v130
  v_max3_f32 v9, v131, v132, v133
  v_max3_f32 v8, v8, v134, v135
  v_max3_f32 v9, v9, v136, v137
  v_max3_f32 v8, v8, v138, v139
  v_max3_f32 v9, v9, v140, v141
  v_mfma_f32_32x32x16_bf16 v[160:175], v[108:111], v[180:183], v[160:175]
  v_max3_f32 v8, v8, v142, v143
  v_mfma_f32_32x32x16_bf16 v[224:239], v[72:75], v[152:155], v[224:239]
  v_mfma_f32_32x32x16_bf16 v[208:223], v[96:99], v[152:155], v[208:223]
  s_nop 8
  v_max3_f32 v9, v9, v160, v161
  v_max3_f32 v8, v8, v162, v163
  v_max3_f32 v9, v9, v164, v165
  v_max3_f32 v8, v8, v166, v167
  v_max3_f32 v9, v9, v168, v169
  v_max3_f32 v8, v8, v170, v171
  v_mfma_f32_32x32x16_bf16 v[224:239], v[76:79], v[156:159], v[224:239]
  v_max3_f32 v9, v9, v172, v173
  v_max3_f32 v8, v8, v174, v175
  v_mfma_f32_32x32x16_bf16 v[208:223], v[100:103], v[156:159], v[208:223]
  v_max_f32 v8, v8, v9
  s_waitcnt lgkmcnt(3)
  v_mfma_f32_32x32x16_bf16 v[112:127], v[64:67], v[240:243], 0
  v_mov_b32 v9, v8
  v_mfma_f32_32x32x16_bf16 v[144:159], v[88:91], v[240:243], 0
  ds_read_b128 v[240:243], v6 offset:24576
  v_permlane32_swap_b32 v8, v9
  s_waitcnt lgkmcnt(3)
  v_mfma_f32_32x32x16_bf16 v[112:127], v[68:71], v[244:247], v[112:127]
  v_max_f32 v8, v8, v9
  v_mfma_f32_32x32x16_bf16 v[144:159], v[92:95], v[244:247], v[144:159]
  ds_read_b128 v[244:247], v6 offset:25600
  v_sub_f32 v128, v128, v8
  v_sub_f32 v129, v129, v8
  v_sub_f32 v130, v130, v8
  v_sub_f32 v131, v131, v8
  v_exp_f32 v128, v128
  s_waitcnt lgkmcnt(3)
  v_mfma_f32_32x32x16_bf16 v[112:127], v[72:75], v[248:251], v[112:127]
  v_exp_f32 v129, v129
  v_exp_f32 v130, v130
  v_exp_f32 v131, v131
  v_mfma_f32_32x32x16_bf16 v[144:159], v[96:99], v[248:251], v[144:159]
  v_sub_f32 v132, v132, v8
  v_sub_f32 v133, v133, v8
  v_exp_f32 v132, v132
  v_exp_f32 v133, v133
  s_waitcnt lgkmcnt(2)
  v_mfma_f32_32x32x16_bf16 v[112:127], v[76:79], v[252:255], v[112:127]
  v_sub_f32 v134, v134, v8
  v_sub_f32 v135, v135, v8
  v_exp_f32 v134, v134
  v_exp_f32 v135, v135
  v_mfma_f32_32x32x16_bf16 v[224:239], v[80:83], v[184:187], v[224:239]
  v_sub_f32 v136, v136, v8
  v_sub_f32 v137, v137, v8
  v_add_f32 v10, v128, v129
  v_add_f32 v11, v130, v131
  v_exp_f32 v136, v136
  v_mfma_f32_32x32x16_bf16 v[144:159], v[100:103], v[252:255], v[144:159]
  v_exp_f32 v137, v137
  v_sub_f32 v138, v138, v8
  v_sub_f32 v139, v139, v8
  v_add_f32 v10, v10, v132
  v_add_f32 v11, v11, v133
  v_mfma_f32_32x32x16_bf16 v[208:223], v[104:107], v[184:187], v[208:223]
  v_exp_f32 v138, v138
  v_exp_f32 v139, v139
  v_sub_f32 v140, v140, v8
  v_sub_f32 v141, v141, v8
  s_waitcnt lgkmcnt(1)
  v_mfma_f32_32x32x16_bf16 v[112:127], v[80:83], v[240:243], v[112:127]
  v_add_f32 v10, v10, v134
  v_add_f32 v11, v11, v135
  v_exp_f32 v140, v140
  v_exp_f32 v141, v141
  v_mfma_f32_32x32x16_bf16 v[224:239], v[84:87], v[188:191], v[224:239]
  v_sub_f32 v142, v142, v8
  v_sub_f32 v143, v143, v8
  v_add_f32 v10, v10, v136
  v_add_f32 v11, v11, v137
  v_exp_f32 v142, v142
  v_mfma_f32_32x32x16_bf16 v[144:159], v[104:107], v[240:243], v[144:159]
  v_exp_f32 v143, v143
  v_sub_f32 v160, v160, v8
  v_sub_f32 v161, v161, v8
  v_add_f32 v10, v10, v138
  v_add_f32 v11, v11, v139
  v_mfma_f32_32x32x16_bf16 v[208:223], v[108:111], v[188:191], v[208:223]
  v_exp_f32 v160, v160
  v_exp_f32 v161, v161
  v_sub_f32 v162, v162, v8
  v_sub_f32 v163, v163, v8
  s_waitcnt lgkmcnt(0)
  v_mfma_f32_32x32x16_bf16 v[112:127], v[84:87], v[244:247], v[112:127]
  v_add_f32 v10, v10, v140
  v_add_f32 v11, v11, v141
  v_exp_f32 v162, v162
  v_exp_f32 v163, v163
  v_mfma_f32_32x32x16_bf16 v[144:159], v[108:111], v[244:247], v[144:159]
  v_sub_f32 v164, v164, v8
  v_sub_f32 v165, v165, v8
  ds_read_b128 v[248:251], v6 offset:26624
  v_add_f32 v10, v10, v142
  v_add_f32 v11, v11, v143
  v_exp_f32 v164, v164
  v_exp_f32 v165, v165
  v_sub_f32 v166, v166, v8
  v_sub_f32 v167, v167, v8
  v_add_f32 v10, v10, v160
  v_add_f32 v11, v11, v161
  v_exp_f32 v166, v166
  v_exp_f32 v167, v167
  v_sub_f32 v168, v168, v8
  v_sub_f32 v169, v169, v8
  v_add_f32 v10, v10, v162
  v_add_f32 v11, v11, v163
  v_exp_f32 v168, v168
  v_exp_f32 v169, v169
  v_sub_f32 v170, v170, v8
  v_sub_f32 v171, v171, v8
  v_add_f32 v10, v10, v164
  v_add_f32 v11, v11, v165
  v_exp_f32 v170, v170
  v_exp_f32 v171, v171
  v_sub_f32 v172, v172, v8
  v_sub_f32 v173, v173, v8
  v_add_f32 v10, v10, v166
  v_add_f32 v11, v11, v167
  s_waitcnt lgkmcnt(0)
  v_mfma_f32_32x32x16_bf16 v[176:191], v[64:67], v[248:251], 0
  ds_read_b128 v[252:255], v6 offset:27648
  v_exp_f32 v172, v172
  v_exp_f32 v173, v173
  v_sub_f32 v174, v174, v8
  v_sub_f32 v175, v175, v8
  v_add_f32 v10, v10, v168
  v_add_f32 v11, v11, v169
  v_exp_f32 v174, v174
  v_exp_f32 v175, v175
  v_add_f32 v10, v10, v170
  v_add_f32 v11, v11, v171
  v_add_f32 v10, v10, v172
  v_add_f32 v11, v11, v173
  v_max3_f32 v12, v224, v225, v226
  v_add_f32 v10, v10, v174
  v_add_f32 v11, v11, v175
  v_max3_f32 v13, v227, v228, v229
  v_max3_f32 v12, v12, v230, v231
  ds_read_b128 v[240:243], v6 offset:28672
  v_add_f32 v10, v10, v11
  v_max3_f32 v13, v13, v232, v233
  v_max3_f32 v12, v12, v234, v235
  v_mov_b32 v9, v10
  v_max3_f32 v13, v13, v236, v237
  v_max3_f32 v12, v12, v238, v239
  v_max3_f32 v13, v13, v208, v209
  v_max3_f32 v12, v12, v210, v211
  v_cvt_pk_bf16_f32 v112, v112, v113
  v_permlane32_swap_b32 v10, v9
  v_max3_f32 v13, v13, v212, v213
  v_max3_f32 v12, v12, v214, v215
  s_waitcnt lgkmcnt(1)
  v_mfma_f32_32x32x16_bf16 v[176:191], v[68:71], v[252:255], v[176:191]
  v_cvt_pk_bf16_f32 v113, v114, v115
  v_add_f32 v10, v10, v9
  v_max3_f32 v13, v13, v216, v217
  v_max3_f32 v12, v12, v218, v219
  v_cvt_pk_bf16_f32 v114, v116, v117
  v_cvt_pk_bf16_f32 v115, v118, v119
  ds_read_b128 v[244:247], v6 offset:29696
  v_rcp_f32 v10, v10
  v_cvt_pk_bf16_f32 v116, v120, v121
  v_cvt_pk_bf16_f32 v117, v122, v123
  v_cvt_pk_bf16_f32 v118, v124, v125
  v_cvt_pk_bf16_f32 v119, v126, v127
  v_max3_f32 v13, v13, v220, v221
  v_max3_f32 v12, v12, v222, v223
  v_cvt_pk_bf16_f32 v120, v144, v145
  v_cvt_pk_bf16_f32 v121, v146, v147
  v_cvt_pk_bf16_f32 v122, v148, v149
  v_cvt_pk_bf16_f32 v123, v150, v151
  v_cvt_pk_bf16_f32 v124, v152, v153
  s_waitcnt lgkmcnt(1)
  v_mfma_f32_32x32x16_bf16 v[176:191], v[72:75], v[240:243], v[176:191]
  v_cvt_pk_bf16_f32 v125, v154, v155
  v_cvt_pk_bf16_f32 v126, v156, v157
  v_cvt_pk_bf16_f32 v127, v158, v159
  v_max_f32 v12, v12, v13
  v_mul_f32 v128, v128, v10
  v_mul_f32 v129, v129, v10
  v_mfma_f32_32x32x16_bf16 v[144:159], v[88:91], v[248:251], 0
  v_mov_b32 v13, v12
  v_mul_f32 v130, v130, v10
  v_mul_f32 v131, v131, v10
  v_cvt_pk_bf16_f32 v128, v128, v129
  ds_read_b128 v[248:251], v6 offset:30720
  v_mul_f32 v132, v132, v10
  v_mfma_f32_32x32x16_bf16 v[144:159], v[92:95], v[252:255], v[144:159]
  v_mul_f32 v133, v133, v10
  v_mul_f32 v134, v134, v10
  v_mul_f32 v135, v135, v10
  v_permlane32_swap_b32 v12, v13
  v_cvt_pk_bf16_f32 v129, v130, v131
  v_mul_f32 v136, v136, v10
  v_mfma_f32_32x32x16_bf16 v[144:159], v[96:99], v[240:243], v[144:159]
  v_mul_f32 v137, v137, v10
  v_mul_f32 v138, v138, v10
  v_mul_f32 v139, v139, v10
  v_mul_f32 v140, v140, v10
  v_mul_f32 v141, v141, v10
  v_mul_f32 v142, v142, v10
  s_waitcnt lgkmcnt(1)
  v_mfma_f32_32x32x16_bf16 v[176:191], v[76:79], v[244:247], v[176:191]
  v_mul_f32 v143, v143, v10
  v_cvt_pk_bf16_f32 v130, v132, v133
  v_cvt_pk_bf16_f32 v131, v134, v135
  v_max_f32 v12, v12, v13
  v_mul_f32 v160, v160, v10
  v_mul_f32 v161, v161, v10
  v_mfma_f32_32x32x16_bf16 v[144:159], v[100:103], v[244:247], v[144:159]
  v_mul_f32 v162, v162, v10
  v_mul_f32 v163, v163, v10
  v_mul_f32 v164, v164, v10
  v_mul_f32 v165, v165, v10
  v_mul_f32 v166, v166, v10
  v_mul_f32 v167, v167, v10
  v_mul_f32 v168, v168, v10
  s_waitcnt lgkmcnt(0)
  v_mfma_f32_32x32x16_bf16 v[176:191], v[80:83], v[248:251], v[176:191]
  v_mul_f32 v169, v169, v10
  v_mul_f32 v170, v170, v10
  v_mul_f32 v171, v171, v10
  v_mul_f32 v172, v172, v10
  v_mul_f32 v173, v173, v10
  v_mul_f32 v174, v174, v10
  v_mfma_f32_32x32x16_bf16 v[144:159], v[104:107], v[248:251], v[144:159]
  v_mul_f32 v175, v175, v10
  v_cvt_pk_bf16_f32 v132, v136, v137
  v_cvt_pk_bf16_f32 v133, v138, v139
  v_cvt_pk_bf16_f32 v134, v140, v141
  v_cvt_pk_bf16_f32 v135, v142, v143
  v_sub_f32 v224, v224, v12
  v_sub_f32 v225, v225, v12
  v_sub_f32 v226, v226, v12
  v_sub_f32 v227, v227, v12
  v_cvt_pk_bf16_f32 v136, v160, v161
  v_cvt_pk_bf16_f32 v137, v162, v163
  v_cvt_pk_bf16_f32 v138, v164, v165
  v_cvt_pk_bf16_f32 v139, v166, v167
  v_cvt_pk_bf16_f32 v140, v168, v169
  v_cvt_pk_bf16_f32 v141, v170, v171
  v_cvt_pk_bf16_f32 v142, v172, v173
  v_cvt_pk_bf16_f32 v143, v174, v175
  v_exp_f32 v224, v224
  v_exp_f32 v225, v225
  v_exp_f32 v226, v226
  v_exp_f32 v227, v227
  v_sub_f32 v228, v228, v12
  v_sub_f32 v229, v229, v12
  v_lshlrev_b32 v160, 16, v16
  v_and_b32 v161, s31, v16
  v_lshlrev_b32 v162, 16, v17
  v_and_b32 v163, s31, v17
  v_lshlrev_b32 v164, 16, v18
  v_and_b32 v165, s31, v18
  v_lshlrev_b32 v166, 16, v19
  v_and_b32 v167, s31, v19
  v_lshlrev_b32 v168, 16, v20
  v_and_b32 v169, s31, v20
  v_lshlrev_b32 v170, 16, v21
  v_and_b32 v171, s31, v21
  v_lshlrev_b32 v172, 16, v22
  v_and_b32 v173, s31, v22
  v_lshlrev_b32 v174, 16, v23
  v_and_b32 v175, s31, v23
  v_exp_f32 v228, v228
  s_nop 0
  v_mfma_f32_32x32x16_bf16 v[160:175], v[192:195], v[128:131], v[160:175]
  v_exp_f32 v229, v229
  v_sub_f32 v230, v230, v12
  v_sub_f32 v231, v231, v12
  ds_read_b128 v[252:255], v6 offset:31744
  v_exp_f32 v230, v230
  v_mfma_f32_32x32x16_bf16 v[160:175], v[196:199], v[132:135], v[160:175]
  v_exp_f32 v231, v231
  v_sub_f32 v232, v232, v12
  v_sub_f32 v233, v233, v12
  v_add_f32 v14, v224, v225
  v_add_f32 v15, v226, v227
  v_mfma_f32_32x32x16_bf16 v[160:175], v[200:203], v[136:139], v[160:175]
  v_exp_f32 v232, v232
  v_exp_f32 v233, v233
  v_sub_f32 v234, v234, v12
  v_sub_f32 v235, v235, v12
  v_mfma_f32_32x32x16_bf16 v[160:175], v[204:207], v[140:143], v[160:175]
  v_add_f32 v14, v14, v228
  v_add_f32 v15, v15, v229
  v_exp_f32 v234, v234
  v_exp_f32 v235, v235
  v_sub_f32 v236, v236, v12
  v_sub_f32 v237, v237, v12
  v_add_f32 v14, v14, v230
  v_add_f32 v15, v15, v231
  v_exp_f32 v236, v236
  v_exp_f32 v237, v237
  s_waitcnt lgkmcnt(0)
  v_mfma_f32_32x32x16_bf16 v[176:191], v[84:87], v[252:255], v[176:191]
  v_sub_f32 v238, v238, v12
  v_sub_f32 v239, v239, v12
  v_add_f32 v14, v14, v232
  v_add_f32 v15, v15, v233
  v_exp_f32 v238, v238
  v_mfma_f32_32x32x16_bf16 v[144:159], v[108:111], v[252:255], v[144:159]
  v_exp_f32 v239, v239
  v_sub_f32 v208, v208, v12
  v_sub_f32 v209, v209, v12
  v_add_f32 v14, v14, v234
  v_add_f32 v15, v15, v235
  v_exp_f32 v208, v208
  v_exp_f32 v209, v209
  v_sub_f32 v210, v210, v12
  v_sub_f32 v211, v211, v12
  v_add_f32 v14, v14, v236
  v_add_f32 v15, v15, v237
  v_exp_f32 v210, v210
  v_exp_f32 v211, v211
  v_sub_f32 v212, v212, v12
  v_sub_f32 v213, v213, v12
  v_add_f32 v14, v14, v238
  v_add_f32 v15, v15, v239
  v_exp_f32 v212, v212
  v_exp_f32 v213, v213
  v_sub_f32 v214, v214, v12
  v_sub_f32 v215, v215, v12
  v_add_f32 v14, v14, v208
  v_add_f32 v15, v15, v209
  v_exp_f32 v214, v214
  v_exp_f32 v215, v215
  v_sub_f32 v216, v216, v12
  v_sub_f32 v217, v217, v12
  v_add_f32 v14, v14, v210
  v_add_f32 v15, v15, v211
  v_exp_f32 v216, v216
  v_exp_f32 v217, v217
  v_sub_f32 v218, v218, v12
  v_sub_f32 v219, v219, v12
  v_add_f32 v14, v14, v212
  v_add_f32 v15, v15, v213
  v_exp_f32 v218, v218
  v_exp_f32 v219, v219
  v_sub_f32 v220, v220, v12
  v_sub_f32 v221, v221, v12
  v_add_f32 v14, v14, v214
  v_add_f32 v15, v15, v215
  v_exp_f32 v220, v220
  v_exp_f32 v221, v221
  v_sub_f32 v222, v222, v12
  v_sub_f32 v223, v223, v12
  v_add_f32 v14, v14, v216
  v_add_f32 v15, v15, v217
  v_exp_f32 v222, v222
  v_exp_f32 v223, v223
  v_add_f32 v14, v14, v218
  v_add_f32 v15, v15, v219
  v_add_f32 v14, v14, v220
  v_add_f32 v15, v15, v221
  v_add_f32 v14, v14, v222
  v_add_f32 v15, v15, v223
  v_cvt_pk_bf16_f32 v160, v160, v161
  v_add_f32 v14, v14, v15
  v_cvt_pk_bf16_f32 v161, v162, v163
  v_mov_b32 v13, v14
  v_cvt_pk_bf16_f32 v176, v176, v177
  v_cvt_pk_bf16_f32 v162, v164, v165
  v_permlane32_swap_b32 v14, v13
  v_cvt_pk_bf16_f32 v163, v166, v167
  v_add_f32 v14, v14, v13
  v_cvt_pk_bf16_f32 v177, v178, v179
  v_rcp_f32 v14, v14
  v_cvt_pk_bf16_f32 v164, v168, v169
  v_mul_f32 v224, v224, v14
  v_mul_f32 v225, v225, v14
  v_mul_f32 v226, v226, v14
  v_mul_f32 v227, v227, v14
  v_cvt_pk_bf16_f32 v224, v224, v225
  v_mul_f32 v228, v228, v14
  v_mul_f32 v229, v229, v14
  v_mul_f32 v230, v230, v14
  v_mul_f32 v231, v231, v14
  v_cvt_pk_bf16_f32 v225, v226, v227
  v_cvt_pk_bf16_f32 v165, v170, v171
  v_cvt_pk_bf16_f32 v166, v172, v173
  v_cvt_pk_bf16_f32 v167, v174, v175
  v_mul_f32 v232, v232, v14
  v_mul_f32 v233, v233, v14
  v_mul_f32 v234, v234, v14
  v_mul_f32 v235, v235, v14
  v_mul_f32 v236, v236, v14
  v_mul_f32 v237, v237, v14
  v_mul_f32 v238, v238, v14
  v_mul_f32 v239, v239, v14
  v_cvt_pk_bf16_f32 v226, v228, v229
  v_cvt_pk_bf16_f32 v227, v230, v231
  v_cvt_pk_bf16_f32 v178, v180, v181
  v_cvt_pk_bf16_f32 v179, v182, v183
  buffer_store_dwordx4 v[160:163], v5, s[16:19], s50 offen offset:0 nt
  buffer_store_dwordx4 v[164:167], v5, s[16:19], s50 offen offset:32 nt
  v_mul_f32 v208, v208, v14
  v_mul_f32 v209, v209, v14
  v_mul_f32 v210, v210, v14
  v_mul_f32 v211, v211, v14
  v_mul_f32 v212, v212, v14
  v_mul_f32 v213, v213, v14
  v_mul_f32 v214, v214, v14
  v_mul_f32 v215, v215, v14
  v_mul_f32 v216, v216, v14
  v_mul_f32 v217, v217, v14
  v_mul_f32 v218, v218, v14
  v_mul_f32 v219, v219, v14
  v_mul_f32 v220, v220, v14
  v_mul_f32 v221, v221, v14
  v_mul_f32 v222, v222, v14
  v_mul_f32 v223, v223, v14
  v_cvt_pk_bf16_f32 v228, v232, v233
  v_cvt_pk_bf16_f32 v229, v234, v235
  v_cvt_pk_bf16_f32 v230, v236, v237
  v_cvt_pk_bf16_f32 v231, v238, v239
  v_cvt_pk_bf16_f32 v180, v184, v185
  v_cvt_pk_bf16_f32 v181, v186, v187
  v_cvt_pk_bf16_f32 v182, v188, v189
  v_cvt_pk_bf16_f32 v183, v190, v191
  v_cvt_pk_bf16_f32 v232, v208, v209
  v_cvt_pk_bf16_f32 v233, v210, v211
  v_cvt_pk_bf16_f32 v234, v212, v213
  v_cvt_pk_bf16_f32 v235, v214, v215
  v_cvt_pk_bf16_f32 v236, v216, v217
  v_cvt_pk_bf16_f32 v237, v218, v219
  v_cvt_pk_bf16_f32 v238, v220, v221
  v_cvt_pk_bf16_f32 v239, v222, v223
  v_cvt_pk_bf16_f32 v184, v144, v145
  v_cvt_pk_bf16_f32 v185, v146, v147
  v_cvt_pk_bf16_f32 v186, v148, v149
  v_cvt_pk_bf16_f32 v187, v150, v151
  v_cvt_pk_bf16_f32 v188, v152, v153
  v_cvt_pk_bf16_f32 v189, v154, v155
  v_cvt_pk_bf16_f32 v190, v156, v157
  v_cvt_pk_bf16_f32 v191, v158, v159
  v_lshlrev_b32 v144, 16, v24
  v_and_b32 v145, s31, v24
  v_lshlrev_b32 v146, 16, v25
  v_and_b32 v147, s31, v25
  v_lshlrev_b32 v148, 16, v26
  v_and_b32 v149, s31, v26
  v_lshlrev_b32 v150, 16, v27
  v_and_b32 v151, s31, v27
  v_lshlrev_b32 v152, 16, v28
  v_and_b32 v153, s31, v28
  v_lshlrev_b32 v154, 16, v29
  v_and_b32 v155, s31, v29
  v_lshlrev_b32 v156, 16, v30
  v_and_b32 v157, s31, v30
  v_lshlrev_b32 v158, 16, v31
  v_and_b32 v159, s31, v31
  v_lshlrev_b32 v208, 16, v32
  v_and_b32 v209, s31, v32
  v_mfma_f32_32x32x16_bf16 v[144:159], v[112:115], v[128:131], v[144:159]
  v_lshlrev_b32 v210, 16, v33
  v_and_b32 v211, s31, v33
  v_lshlrev_b32 v212, 16, v34
  v_and_b32 v213, s31, v34
  v_lshlrev_b32 v214, 16, v35
  v_and_b32 v215, s31, v35
  v_mfma_f32_32x32x16_bf16 v[144:159], v[116:119], v[132:135], v[144:159]
  v_lshlrev_b32 v216, 16, v36
  v_and_b32 v217, s31, v36
  v_lshlrev_b32 v218, 16, v37
  v_and_b32 v219, s31, v37
  v_lshlrev_b32 v220, 16, v38
  v_and_b32 v221, s31, v38
  v_mfma_f32_32x32x16_bf16 v[144:159], v[120:123], v[136:139], v[144:159]
  v_lshlrev_b32 v222, 16, v39
  v_and_b32 v223, s31, v39
  v_lshlrev_b32 v64, 16, v40
  v_and_b32 v65, s31, v40
  v_lshlrev_b32 v66, 16, v41
  v_and_b32 v67, s31, v41
  v_mfma_f32_32x32x16_bf16 v[208:223], v[176:179], v[128:131], v[208:223]
  v_lshlrev_b32 v68, 16, v42
  v_and_b32 v69, s31, v42
  v_lshlrev_b32 v70, 16, v43
  v_and_b32 v71, s31, v43
  v_lshlrev_b32 v72, 16, v44
  v_and_b32 v73, s31, v44
  v_mfma_f32_32x32x16_bf16 v[208:223], v[180:183], v[132:135], v[208:223]
  v_lshlrev_b32 v74, 16, v45
  v_and_b32 v75, s31, v45
  v_lshlrev_b32 v76, 16, v46
  v_and_b32 v77, s31, v46
  v_lshlrev_b32 v78, 16, v47
  v_and_b32 v79, s31, v47
  v_mfma_f32_32x32x16_bf16 v[208:223], v[184:187], v[136:139], v[208:223]
  v_lshlrev_b32 v80, 16, v48
  v_and_b32 v81, s31, v48
  v_lshlrev_b32 v82, 16, v49
  v_and_b32 v83, s31, v49
  v_lshlrev_b32 v84, 16, v50
  v_and_b32 v85, s31, v50
  v_mfma_f32_32x32x16_bf16 v[64:79], v[192:195], v[224:227], v[64:79]
  v_lshlrev_b32 v86, 16, v51
  v_and_b32 v87, s31, v51
  v_lshlrev_b32 v88, 16, v52
  v_and_b32 v89, s31, v52
  v_lshlrev_b32 v90, 16, v53
  v_and_b32 v91, s31, v53
  v_mfma_f32_32x32x16_bf16 v[64:79], v[196:199], v[228:231], v[64:79]
  v_lshlrev_b32 v92, 16, v54
  v_and_b32 v93, s31, v54
  v_lshlrev_b32 v94, 16, v55
  v_and_b32 v95, s31, v55
  v_lshlrev_b32 v160, 16, v56
  v_and_b32 v161, s31, v56
  v_mfma_f32_32x32x16_bf16 v[80:95], v[112:115], v[224:227], v[80:95]
  v_lshlrev_b32 v162, 16, v57
  v_and_b32 v163, s31, v57
  v_lshlrev_b32 v164, 16, v58
  v_and_b32 v165, s31, v58
  v_lshlrev_b32 v166, 16, v59
  v_and_b32 v167, s31, v59
  v_mfma_f32_32x32x16_bf16 v[80:95], v[116:119], v[228:231], v[80:95]
  v_lshlrev_b32 v168, 16, v60
  v_and_b32 v169, s31, v60
  v_lshlrev_b32 v170, 16, v61
  v_and_b32 v171, s31, v61
  v_lshlrev_b32 v172, 16, v62
  v_and_b32 v173, s31, v62
  v_mfma_f32_32x32x16_bf16 v[64:79], v[200:203], v[232:235], v[64:79]
  v_lshlrev_b32 v174, 16, v63
  v_and_b32 v175, s31, v63
  s_nop 0
  s_nop 0
  v_mfma_f32_32x32x16_bf16 v[160:175], v[176:179], v[224:227], v[160:175]
  v_mfma_f32_32x32x16_bf16 v[160:175], v[180:183], v[228:231], v[160:175]
  v_mfma_f32_32x32x16_bf16 v[80:95], v[120:123], v[232:235], v[80:95]
  v_mfma_f32_32x32x16_bf16 v[160:175], v[184:187], v[232:235], v[160:175]
  v_mfma_f32_32x32x16_bf16 v[144:159], v[124:127], v[140:143], v[144:159]
  v_mfma_f32_32x32x16_bf16 v[208:223], v[188:191], v[140:143], v[208:223]
  v_mfma_f32_32x32x16_bf16 v[64:79], v[204:207], v[236:239], v[64:79]
  s_nop 9
  v_cvt_pk_bf16_f32 v144, v144, v145
  v_cvt_pk_bf16_f32 v145, v146, v147
  v_cvt_pk_bf16_f32 v146, v148, v149
  v_cvt_pk_bf16_f32 v147, v150, v151
  v_cvt_pk_bf16_f32 v148, v152, v153
  v_cvt_pk_bf16_f32 v149, v154, v155
  v_mfma_f32_32x32x16_bf16 v[80:95], v[124:127], v[236:239], v[80:95]
  v_cvt_pk_bf16_f32 v208, v208, v209
  v_cvt_pk_bf16_f32 v209, v210, v211
  v_cvt_pk_bf16_f32 v210, v212, v213
  v_cvt_pk_bf16_f32 v211, v214, v215
  v_cvt_pk_bf16_f32 v150, v156, v157
  v_cvt_pk_bf16_f32 v151, v158, v159
  v_mfma_f32_32x32x16_bf16 v[160:175], v[188:191], v[236:239], v[160:175]
  v_cvt_pk_bf16_f32 v64, v64, v65
  v_cvt_pk_bf16_f32 v65, v66, v67
  v_cvt_pk_bf16_f32 v66, v68, v69
  v_cvt_pk_bf16_f32 v67, v70, v71
  v_cvt_pk_bf16_f32 v212, v216, v217
  v_cvt_pk_bf16_f32 v213, v218, v219
  v_cvt_pk_bf16_f32 v80, v80, v81
  v_cvt_pk_bf16_f32 v81, v82, v83
  v_cvt_pk_bf16_f32 v82, v84, v85
  v_cvt_pk_bf16_f32 v83, v86, v87
  v_cvt_pk_bf16_f32 v214, v220, v221
  v_cvt_pk_bf16_f32 v215, v222, v223
  v_cvt_pk_bf16_f32 v68, v72, v73
  v_cvt_pk_bf16_f32 v69, v74, v75
  v_cvt_pk_bf16_f32 v160, v160, v161
  v_cvt_pk_bf16_f32 v161, v162, v163
  v_cvt_pk_bf16_f32 v162, v164, v165
  v_cvt_pk_bf16_f32 v163, v166, v167
  v_cvt_pk_bf16_f32 v70, v76, v77
  v_cvt_pk_bf16_f32 v71, v78, v79
  v_cvt_pk_bf16_f32 v84, v88, v89
  v_cvt_pk_bf16_f32 v85, v90, v91
  v_cvt_pk_bf16_f32 v86, v92, v93
  v_cvt_pk_bf16_f32 v87, v94, v95
  v_cvt_pk_bf16_f32 v164, v168, v169
  v_cvt_pk_bf16_f32 v165, v170, v171
  v_cvt_pk_bf16_f32 v166, v172, v173
  v_cvt_pk_bf16_f32 v167, v174, v175
  buffer_store_dwordx4 v[144:147], v5, s[16:19], s50 offen offset:64 nt
  buffer_store_dwordx4 v[148:151], v5, s[16:19], s50 offen offset:96 nt
  buffer_store_dwordx4 v[208:211], v5, s[16:19], s50 offen offset:128 nt
  buffer_store_dwordx4 v[212:215], v5, s[16:19], s50 offen offset:160 nt
  buffer_store_dwordx4 v[64:67], v5, s[16:19], s51 offen offset:0 nt
  buffer_store_dwordx4 v[68:71], v5, s[16:19], s51 offen offset:32 nt
  buffer_store_dwordx4 v[80:83], v5, s[16:19], s51 offen offset:64 nt
  buffer_store_dwordx4 v[84:87], v5, s[16:19], s51 offen offset:96 nt
  buffer_store_dwordx4 v[160:163], v5, s[16:19], s51 offen offset:128 nt
  buffer_store_dwordx4 v[164:167], v5, s[16:19], s51 offen offset:160 nt
  s_waitcnt vmcnt(12)
L_main_done:
  s_endpgm
L_Ttail:
  s_mul_i32 s48, s24, 12288
  s_add_u32 s48, s48, 32768
  v_add_u32 v8, s48, v6
  ds_read_b128 v[16:19], v8 offset:0
  ds_read_b128 v[20:23], v8 offset:1024
  ds_read_b128 v[24:27], v8 offset:2048
  ds_read_b128 v[28:31], v8 offset:3072
  ds_read_b128 v[32:35], v8 offset:4096
  ds_read_b128 v[36:39], v8 offset:5120
  ds_read_b128 v[40:43], v8 offset:6144
  ds_read_b128 v[44:47], v8 offset:7168
  ds_read_b128 v[48:51], v8 offset:8192
  ds_read_b128 v[52:55], v8 offset:9216
  ds_read_b128 v[56:59], v8 offset:10240
  ds_read_b128 v[60:63], v8 offset:11264
  s_waitcnt lgkmcnt(0)
  buffer_store_dwordx4 v[16:19], v6, s[20:23], s63 offen offset:0 sc0 sc1
  buffer_store_dwordx4 v[20:23], v6, s[20:23], s63 offen offset:1024 sc0 sc1
  buffer_store_dwordx4 v[24:27], v6, s[20:23], s63 offen offset:2048 sc0 sc1
  buffer_store_dwordx4 v[28:31], v6, s[20:23], s63 offen offset:3072 sc0 sc1
  s_add_u32 s63, s63, 4096
  buffer_store_dwordx4 v[32:35], v6, s[20:23], s63 offen offset:0 sc0 sc1
  buffer_store_dwordx4 v[36:39], v6, s[20:23], s63 offen offset:1024 sc0 sc1
  buffer_store_dwordx4 v[40:43], v6, s[20:23], s63 offen offset:2048 sc0 sc1
  buffer_store_dwordx4 v[44:47], v6, s[20:23], s63 offen offset:3072 sc0 sc1
  s_add_u32 s63, s63, 4096
  buffer_store_dwordx4 v[48:51], v6, s[20:23], s63 offen offset:0 sc0 sc1
  buffer_store_dwordx4 v[52:55], v6, s[20:23], s63 offen offset:1024 sc0 sc1
  buffer_store_dwordx4 v[56:59], v6, s[20:23], s63 offen offset:2048 sc0 sc1
  buffer_store_dwordx4 v[60:63], v6, s[20:23], s63 offen offset:3072 sc0 sc1
  s_waitcnt vmcnt(0)
  s_barrier
  s_cmp_eq_u32 s24, 0
  s_cbranch_scc0 L_main_done
  v_mov_b32 v8, s62
  v_mov_b32 v9, 1
  v_cmp_eq_u32 vcc, 0, v1
  s_and_saveexec_b64 s[82:83], vcc
  global_store_byte v8, v9, s[8:9] sc0 sc1
  s_endpgm
L_Shead:
  buffer_load_dwordx4 v[64:67], v7, s[20:23], s52 offen
  buffer_load_dwordx4 v[68:71], v7, s[20:23], s53 offen
  buffer_load_dwordx4 v[72:75], v7, s[20:23], s54 offen
  buffer_load_dwordx4 v[76:79], v7, s[20:23], s55 offen
  buffer_load_dwordx4 v[80:83], v7, s[20:23], s56 offen
  buffer_load_dwordx4 v[84:87], v7, s[20:23], s57 offen
  buffer_load_dwordx4 v[88:91], v7, s[20:23], s58 offen
  buffer_load_dwordx4 v[92:95], v7, s[20:23], s59 offen
  buffer_load_dwordx4 v[240:243], v6, s[20:23], s60 offen offset:0
  buffer_load_dwordx4 v[244:247], v6, s[20:23], s60 offen offset:1024
  buffer_load_dwordx4 v[248:251], v6, s[20:23], s60 offen offset:2048
  buffer_load_dwordx4 v[252:255], v6, s[20:23], s60 offen offset:3072
  v_mov_b32 v8, s62
L_Spoll:
  global_load_ubyte v9, v8, s[8:9] sc0 sc1
  s_waitcnt vmcnt(0)
  v_readfirstlane_b32 s48, v9
  s_nop 3
  s_cmp_eq_u32 s48, 0
  s_cbranch_scc0 L_Sgo
  s_sleep 8
  s_branch L_Spoll
L_Sgo:
  buffer_inv sc1
  s_waitcnt vmcnt(0)
  s_mul_i32 s48, s24, 12288
  s_add_u32 s48, s48, 32768
  s_add_u32 m0, s48, 0
  s_add_u32 s49, s63, 0
  buffer_load_dwordx4 v6, s[20:23], s49 offen sc0 sc1 lds
  s_add_u32 m0, s48, 1024
  s_add_u32 s49, s63, 1024
  buffer_load_dwordx4 v6, s[20:23], s49 offen sc0 sc1 lds
  s_add_u32 m0, s48, 2048
  s_add_u32 s49, s63, 2048
  buffer_load_dwordx4 v6, s[20:23], s49 offen sc0 sc1 lds
  s_add_u32 m0, s48, 3072
  s_add_u32 s49, s63, 3072
  buffer_load_dwordx4 v6, s[20:23], s49 offen sc0 sc1 lds
  s_add_u32 m0, s48, 4096
  s_add_u32 s49, s63, 4096
  buffer_load_dwordx4 v6, s[20:23], s49 offen sc0 sc1 lds
  s_add_u32 m0, s48, 5120
  s_add_u32 s49, s63, 5120
  buffer_load_dwordx4 v6, s[20:23], s49 offen sc0 sc1 lds
  s_add_u32 m0, s48, 6144
  s_add_u32 s49, s63, 6144
  buffer_load_dwordx4 v6, s[20:23], s49 offen sc0 sc1 lds
  s_add_u32 m0, s48, 7168
  s_add_u32 s49, s63, 7168
  buffer_load_dwordx4 v6, s[20:23], s49 offen sc0 sc1 lds
  s_add_u32 m0, s48, 8192
  s_add_u32 s49, s63, 8192
  buffer_load_dwordx4 v6, s[20:23], s49 offen sc0 sc1 lds
  s_add_u32 m0, s48, 9216
  s_add_u32 s49, s63, 9216
  buffer_load_dwordx4 v6, s[20:23], s49 offen sc0 sc1 lds
  s_add_u32 m0, s48, 10240
  s_add_u32 s49, s63, 10240
  buffer_load_dwordx4 v6, s[20:23], s49 offen sc0 sc1 lds
  s_add_u32 m0, s48, 11264
  s_add_u32 s49, s63, 11264
  buffer_load_dwordx4 v6, s[20:23], s49 offen sc0 sc1 lds
  s_waitcnt vmcnt(0)
  s_branch L_R2
.section .rodata,"a"
.p2align 6
.amdhsa_kernel fold_kernel
  .amdhsa_next_free_vgpr 144
  .amdhsa_next_free_sgpr 40
  .amdhsa_accum_offset 144
  .amdhsa_group_segment_fixed_size 0
  .amdhsa_kernarg_size 64
  .amdhsa_user_sgpr_count 2
  .amdhsa_user_sgpr_kernarg_segment_ptr 1
  .amdhsa_system_sgpr_workgroup_id_x 1
.end_amdhsa_kernel
.p2align 6
.amdhsa_kernel standalone__video_video_swin__vision_kernel
  .amdhsa_next_free_vgpr 256
  .amdhsa_next_free_sgpr 102
  .amdhsa_accum_offset 256
  .amdhsa_group_segment_fixed_size 0
  .amdhsa_kernarg_size 64
  .amdhsa_user_sgpr_count 2
  .amdhsa_user_sgpr_kernarg_segment_ptr 1
  .amdhsa_system_sgpr_workgroup_id_x 1
.end_amdhsa_kernel
```
